```python
import torch

def _softmax(x, axis=-1):
    return torch.softmax(x, dim=axis)
def _gelu(x):
    return torch.nn.functional.gelu(x, approximate="tanh")
def _silu(x):
    return torch.nn.functional.silu(x)
def _sigmoid(x):
    return torch.sigmoid(x)
def _layernorm(x, axis=-1, eps=1e-5):
    m = x.mean(dim=axis, keepdim=True)
    v = x.var(dim=axis, keepdim=True, unbiased=False)
    return (x - m) / torch.sqrt(v + eps)
def _scatter_add(tgt, idx, src, axis=0):
    return tgt.clone().index_add_(axis, idx, src)
def _segment_sum(src, seg, n):
    out = torch.zeros((n,) + src.shape[1:], dtype=src.dtype)
    return out.index_add_(0, seg, src)
def _pad(x, pw):
    flat = tuple(v for pair in reversed(pw) for v in pair)
    return torch.nn.functional.pad(x, flat)

kernel_name = 'gated_mix__mha_block_cached__swiglu_ffn__decode'

def setup_inputs():

    _w = (lambda a: (lambda t: t.to(torch.bfloat16) if t.is_floating_point() else t)(torch.as_tensor(a)))
    def _A_setup():
        B, Sq, D = 4, 1, 640
        H, Sk, Dh = 32, 4096, 128
        return {
            "x": _w((lambda *s: torch.randn(*s, dtype=torch.bfloat16) * 0.05)(B, Sq, D)),
            "k_cache": _w((lambda *s: torch.randn(*s, dtype=torch.bfloat16) * 6.4)(B, H, Sk, Dh)),
            "v_cache": _w((lambda *s: torch.randn(*s, dtype=torch.bfloat16) * 0.2)(B, H, Sk, Dh)),
            "wq": _w((lambda *s: torch.randn(*s, dtype=torch.bfloat16) * 6.4)(D, H * Dh) * (D ** -0.5)),
            "wo": _w((lambda *s: torch.randn(*s, dtype=torch.bfloat16) * 0.2)(H * Dh, D) * ((H * Dh) ** -0.5)),
        }
    _A_in = _A_setup()

    def _B_setup():
        B, S, D, F = 4, 1, 640, 1728
        return {
            "x": _w((lambda *s: torch.randn(*s, dtype=torch.bfloat16) * 0.05)(B, S, D)),
            "w_gate": _w((lambda *s: torch.randn(*s, dtype=torch.bfloat16) * 0.05)(D, F)),
            "w_up": _w((lambda *s: torch.randn(*s, dtype=torch.bfloat16) * 0.05)(D, F)),
            "w_down": _w((lambda *s: torch.randn(*s, dtype=torch.bfloat16) * 0.05)(F, D)),
        }
    _B_in = _B_setup()

    return {
        "A_x": _A_in["x"],
        "A_k_cache": _A_in["k_cache"],
        "A_v_cache": _A_in["v_cache"],
        "A_wq": _A_in["wq"],
        "A_wo": _A_in["wo"],
        "B_x": _B_in["x"],
        "B_w_gate": _B_in["w_gate"],
        "B_w_up": _B_in["w_up"],
        "B_w_down": _B_in["w_down"],
        "gate_w": _w((lambda *s: torch.randn(*s, dtype=torch.bfloat16) * 0.05)(640) * 16.0),
    }

def reference(A_x, A_k_cache, A_v_cache, A_wq, A_wo, B_x, B_w_gate, B_w_up, B_w_down, gate_w):
    def _A_ref(x, k_cache, v_cache, wq, wo):
        B, Sq, D = x.shape
        H, Dh = 32, 128
        q = (lambda x, *d: x.permute(*d))((x @ wq).reshape(B, Sq, H, Dh), 0, 2, 1, 3)
        scores = torch.einsum("bhqd,bhkd->bhqk", q, k_cache) * (Dh ** -0.5)
        p = _softmax(scores, axis=-1)
        o = torch.einsum("bhqk,bhkd->bhqd", p, v_cache)
        return (lambda x, *d: x.permute(*d))(o, 0, 2, 1, 3).reshape(B, Sq, H * Dh) @ wo

    def _B_ref(x, w_gate, w_up, w_down):
        g = _silu(x @ w_gate)
        u = x @ w_up
        return (g * u) @ w_down

    x = A_x
    g = _sigmoid((x * gate_w).sum(-1, keepdims=True))
    a = _A_ref(x, A_k_cache, A_v_cache, A_wq, A_wo)
    b = _B_ref(x, B_w_gate, B_w_up, B_w_down)
    return g * a + (1 - g) * b
```

```asm
; @launch grid=(256,1,1) block=(512,1,1) lds=63744
.amdgcn_target "amdgcn-amd-amdhsa--gfx950"
.text
.globl gated_mix__mha_block_cached__swiglu_ffn__decode_kernel
.p2align 8
.type gated_mix__mha_block_cached__swiglu_ffn__decode_kernel,@function
gated_mix__mha_block_cached__swiglu_ffn__decode_kernel:
s_cmp_ge_u32 s2, 256
s_cbranch_scc1 L_end
s_load_dwordx16 s[16:31], s[0:1], 0
s_load_dwordx8 s[32:39], s[0:1], 64
s_load_dwordx2 s[40:41], s[0:1], 96
v_lshrrev_b32 v3, 6, v0
v_and_b32 v1, 63, v0
v_readfirstlane_b32 s3, v3
v_mov_b32 v4, 0
v_mov_b32 v5, 0
v_mov_b32 v6, 0
v_mov_b32 v7, 0
s_cmp_eq_u32 s3, 4
s_cbranch_scc0 L_noz
s_mov_b64 exec, 1
ds_write_b128 v4, v[4:7] offset:0
ds_write_b128 v4, v[4:7] offset:16
s_mov_b64 exec, -1
s_waitcnt lgkmcnt(0)
L_noz:
s_barrier
s_and_b32 s4, s2, 31
s_lshr_b32 s5, s2, 6
s_bfe_u32 s6, s2, 0x10005
s_lshl_b32 s7, s5, 5
s_add_u32 s7, s7, s4
v_lshrrev_b32 v34, 4, v1
v_and_b32 v35, 15, v1
s_cmp_ge_u32 s3, 4
s_cbranch_scc1 L_H
s_lshl_b32 s9, s3, 12
v_lshlrev_b32 v2, 4, v1
v_add_u32 v2, s9, v2
s_lshl_b32 s8, s7, 20
s_cmp_eq_u32 s6, 0
s_cselect_b32 s64, 0, 1032192
s_mov_b32 s9, 16384
s_cselect_b32 s43, s9, 0xffffc000
s_waitcnt lgkmcnt(0)
s_add_u32 s52, s18, s8
s_addc_u32 s53, s19, 0
s_and_b32 s53, s53, 0xffff
s_mov_b32 s54, 0x100000
s_mov_b32 s55, 0x20000
s_add_u32 s56, s20, s8
s_addc_u32 s57, s21, 0
s_and_b32 s57, s57, 0xffff
s_mov_b32 s58, 0x100000
s_mov_b32 s59, 0x20000
s_mov_b32 s65, s64
buffer_load_dwordx4 v[128:131], v2, s[52:55], s65 offen offset:0 nt
buffer_load_dwordx4 v[132:135], v2, s[52:55], s65 offen offset:1024 nt
buffer_load_dwordx4 v[136:139], v2, s[52:55], s65 offen offset:2048 nt
buffer_load_dwordx4 v[140:143], v2, s[52:55], s65 offen offset:3072 nt
s_add_u32 s65, s65, s43
buffer_load_dwordx4 v[144:147], v2, s[52:55], s65 offen offset:0 nt
buffer_load_dwordx4 v[148:151], v2, s[52:55], s65 offen offset:1024 nt
s_waitcnt vmcnt(5)
buffer_load_dwordx4 v[152:155], v2, s[52:55], s65 offen offset:2048 nt
s_waitcnt vmcnt(5)
buffer_load_dwordx4 v[156:159], v2, s[52:55], s65 offen offset:3072 nt
s_waitcnt vmcnt(5)
s_add_u32 s65, s65, s43
buffer_load_dwordx4 v[160:163], v2, s[52:55], s65 offen offset:0 nt
s_waitcnt vmcnt(5)
buffer_load_dwordx4 v[164:167], v2, s[52:55], s65 offen offset:1024 nt
s_waitcnt vmcnt(5)
buffer_load_dwordx4 v[168:171], v2, s[52:55], s65 offen offset:2048 nt
s_waitcnt vmcnt(5)
buffer_load_dwordx4 v[172:175], v2, s[52:55], s65 offen offset:3072 nt
s_waitcnt vmcnt(5)
s_add_u32 s65, s65, s43
buffer_load_dwordx4 v[176:179], v2, s[52:55], s65 offen offset:0 nt
s_waitcnt vmcnt(5)
buffer_load_dwordx4 v[180:183], v2, s[52:55], s65 offen offset:1024 nt
s_waitcnt vmcnt(5)
buffer_load_dwordx4 v[184:187], v2, s[52:55], s65 offen offset:2048 nt
s_waitcnt vmcnt(5)
buffer_load_dwordx4 v[188:191], v2, s[52:55], s65 offen offset:3072 nt
s_waitcnt vmcnt(5)
s_add_u32 s65, s65, s43
buffer_load_dwordx4 v[192:195], v2, s[52:55], s65 offen offset:0 nt
s_waitcnt vmcnt(5)
buffer_load_dwordx4 v[196:199], v2, s[52:55], s65 offen offset:1024 nt
s_waitcnt vmcnt(5)
buffer_load_dwordx4 v[200:203], v2, s[52:55], s65 offen offset:2048 nt
s_waitcnt vmcnt(5)
buffer_load_dwordx4 v[204:207], v2, s[52:55], s65 offen offset:3072 nt
s_waitcnt vmcnt(5)
s_add_u32 s65, s65, s43
buffer_load_dwordx4 v[208:211], v2, s[52:55], s65 offen offset:0 nt
s_waitcnt vmcnt(5)
buffer_load_dwordx4 v[212:215], v2, s[52:55], s65 offen offset:1024 nt
s_waitcnt vmcnt(5)
buffer_load_dwordx4 v[216:219], v2, s[52:55], s65 offen offset:2048 nt
s_waitcnt vmcnt(5)
buffer_load_dwordx4 v[220:223], v2, s[52:55], s65 offen offset:3072 nt
s_waitcnt vmcnt(5)
s_add_u32 s65, s65, s43
buffer_load_dwordx4 v[224:227], v2, s[52:55], s65 offen offset:0 nt
s_waitcnt vmcnt(5)
buffer_load_dwordx4 v[228:231], v2, s[52:55], s65 offen offset:1024 nt
s_waitcnt vmcnt(5)
buffer_load_dwordx4 v[232:235], v2, s[52:55], s65 offen offset:2048 nt
s_waitcnt vmcnt(5)
buffer_load_dwordx4 v[236:239], v2, s[52:55], s65 offen offset:3072 nt
s_waitcnt vmcnt(5)
s_add_u32 s65, s65, s43
buffer_load_dwordx4 v[240:243], v2, s[52:55], s65 offen offset:0 nt
s_waitcnt vmcnt(5)
buffer_load_dwordx4 v[244:247], v2, s[52:55], s65 offen offset:1024 nt
s_waitcnt vmcnt(5)
buffer_load_dwordx4 v[248:251], v2, s[52:55], s65 offen offset:2048 nt
s_waitcnt vmcnt(5)
buffer_load_dwordx4 v[252:255], v2, s[52:55], s65 offen offset:3072 nt
v_and_b32 v44, 1, v35
v_cmp_eq_u32 vcc, 1, v44
v_mov_b32 v45, 0x0000ffff
v_mov_b32 v46, 0xffff0000
v_cndmask_b32 v47, v45, v46, vcc
v_bfe_u32 v44, v35, 1, 2
v_mov_b32 v46, 0
v_cmp_eq_u32 vcc, 0, v44
s_nop 1
v_cndmask_b32 v36, v46, v47, vcc
v_cmp_eq_u32 vcc, 1, v44
s_nop 1
v_cndmask_b32 v37, v46, v47, vcc
v_cmp_eq_u32 vcc, 2, v44
s_nop 1
v_cndmask_b32 v38, v46, v47, vcc
v_cmp_eq_u32 vcc, 3, v44
s_nop 1
v_cndmask_b32 v39, v46, v47, vcc
s_mov_b32 s42, 0x3e0293ee
s_mov_b32 s66, 0xcccccccc
s_mov_b32 s67, 0xcccccccc
s_mov_b32 s68, 0xaaaaaaaa
s_mov_b32 s69, 0xaaaaaaaa
v_mov_b32 v17, 0
v_mov_b32 v18, 0
v_mov_b32 v19, 1
s_mov_b32 s76, 0
v_mov_b32 v44, 0
s_mov_b32 s73, 200000
L_sp1:
ds_read_b32 v45, v44 offset:12
s_waitcnt lgkmcnt(0)
v_readfirstlane_b32 s8, v45
s_cmp_lg_u32 s8, 0
s_cbranch_scc1 L_sp1_ok
s_sleep 2
s_sub_u32 s73, s73, 1
s_cbranch_scc0 L_sp1
L_sp1_ok:
v_lshlrev_b32 v46, 4, v35
ds_read_b128 v[40:43], v46 offset:128
ds_read_b32 v16, v44 offset:32
s_waitcnt lgkmcnt(0)
v_dot2_f32_bf16 v48, v128, v40, 0
v_dot2_f32_bf16 v49, v132, v40, 0
v_dot2_f32_bf16 v48, v129, v41, v48
v_dot2_f32_bf16 v49, v133, v41, v49
v_dot2_f32_bf16 v48, v130, v42, v48
v_dot2_f32_bf16 v49, v134, v42, v49
v_dot2_f32_bf16 v48, v131, v43, v48
v_dot2_f32_bf16 v49, v135, v43, v49
s_waitcnt vmcnt(5)
s_add_u32 s65, s65, s43
buffer_load_dwordx4 v[128:131], v2, s[52:55], s65 offen offset:0 nt
s_waitcnt vmcnt(5)
buffer_load_dwordx4 v[132:135], v2, s[52:55], s65 offen offset:1024 nt
v_dot2_f32_bf16 v50, v136, v40, 0
v_dot2_f32_bf16 v51, v140, v40, 0
v_dot2_f32_bf16 v50, v137, v41, v50
v_dot2_f32_bf16 v51, v141, v41, v51
v_dot2_f32_bf16 v50, v138, v42, v50
v_dot2_f32_bf16 v51, v142, v42, v51
v_dot2_f32_bf16 v50, v139, v43, v50
v_dot2_f32_bf16 v51, v143, v43, v51
s_waitcnt vmcnt(5)
buffer_load_dwordx4 v[136:139], v2, s[52:55], s65 offen offset:2048 nt
s_waitcnt vmcnt(5)
buffer_load_dwordx4 v[140:143], v2, s[52:55], s65 offen offset:3072 nt
v_dot2_f32_bf16 v52, v144, v40, 0
v_dot2_f32_bf16 v53, v148, v40, 0
v_dot2_f32_bf16 v52, v145, v41, v52
v_dot2_f32_bf16 v53, v149, v41, v53
v_dot2_f32_bf16 v52, v146, v42, v52
v_dot2_f32_bf16 v53, v150, v42, v53
v_dot2_f32_bf16 v52, v147, v43, v52
v_dot2_f32_bf16 v53, v151, v43, v53
s_waitcnt vmcnt(5)
s_add_u32 s65, s65, s43
buffer_load_dwordx4 v[144:147], v2, s[52:55], s65 offen offset:0 nt
s_waitcnt vmcnt(5)
buffer_load_dwordx4 v[148:151], v2, s[52:55], s65 offen offset:1024 nt
v_dot2_f32_bf16 v54, v152, v40, 0
v_dot2_f32_bf16 v55, v156, v40, 0
v_dot2_f32_bf16 v54, v153, v41, v54
v_dot2_f32_bf16 v55, v157, v41, v55
v_dot2_f32_bf16 v54, v154, v42, v54
v_dot2_f32_bf16 v55, v158, v42, v55
v_dot2_f32_bf16 v54, v155, v43, v54
v_dot2_f32_bf16 v55, v159, v43, v55
s_waitcnt vmcnt(5)
buffer_load_dwordx4 v[152:155], v2, s[52:55], s65 offen offset:2048 nt
s_waitcnt vmcnt(5)
buffer_load_dwordx4 v[156:159], v2, s[52:55], s65 offen offset:3072 nt
v_dot2_f32_bf16 v56, v160, v40, 0
v_dot2_f32_bf16 v57, v164, v40, 0
v_dot2_f32_bf16 v56, v161, v41, v56
v_dot2_f32_bf16 v57, v165, v41, v57
v_dot2_f32_bf16 v56, v162, v42, v56
v_dot2_f32_bf16 v57, v166, v42, v57
v_dot2_f32_bf16 v56, v163, v43, v56
v_dot2_f32_bf16 v57, v167, v43, v57
s_waitcnt vmcnt(5)
s_add_u32 s65, s65, s43
buffer_load_dwordx4 v[160:163], v2, s[52:55], s65 offen offset:0 nt
s_waitcnt vmcnt(5)
buffer_load_dwordx4 v[164:167], v2, s[52:55], s65 offen offset:1024 nt
v_dot2_f32_bf16 v58, v168, v40, 0
v_dot2_f32_bf16 v59, v172, v40, 0
v_dot2_f32_bf16 v58, v169, v41, v58
v_dot2_f32_bf16 v59, v173, v41, v59
v_dot2_f32_bf16 v58, v170, v42, v58
v_dot2_f32_bf16 v59, v174, v42, v59
v_dot2_f32_bf16 v58, v171, v43, v58
v_dot2_f32_bf16 v59, v175, v43, v59
s_waitcnt vmcnt(5)
buffer_load_dwordx4 v[168:171], v2, s[52:55], s65 offen offset:2048 nt
s_waitcnt vmcnt(5)
buffer_load_dwordx4 v[172:175], v2, s[52:55], s65 offen offset:3072 nt
v_dot2_f32_bf16 v60, v176, v40, 0
v_dot2_f32_bf16 v61, v180, v40, 0
v_dot2_f32_bf16 v60, v177, v41, v60
v_dot2_f32_bf16 v61, v181, v41, v61
v_dot2_f32_bf16 v60, v178, v42, v60
v_dot2_f32_bf16 v61, v182, v42, v61
v_dot2_f32_bf16 v60, v179, v43, v60
v_dot2_f32_bf16 v61, v183, v43, v61
s_waitcnt vmcnt(5)
s_add_u32 s65, s65, s43
buffer_load_dwordx4 v[176:179], v2, s[52:55], s65 offen offset:0 nt
s_waitcnt vmcnt(5)
buffer_load_dwordx4 v[180:183], v2, s[52:55], s65 offen offset:1024 nt
v_dot2_f32_bf16 v62, v184, v40, 0
v_dot2_f32_bf16 v63, v188, v40, 0
v_dot2_f32_bf16 v62, v185, v41, v62
v_dot2_f32_bf16 v63, v189, v41, v63
v_dot2_f32_bf16 v62, v186, v42, v62
v_dot2_f32_bf16 v63, v190, v42, v63
v_dot2_f32_bf16 v62, v187, v43, v62
v_dot2_f32_bf16 v63, v191, v43, v63
s_waitcnt vmcnt(5)
buffer_load_dwordx4 v[184:187], v2, s[52:55], s65 offen offset:2048 nt
s_waitcnt vmcnt(5)
buffer_load_dwordx4 v[188:191], v2, s[52:55], s65 offen offset:3072 nt
v_add_f32_dpp v48, v48, v48 row_ror:8 row_mask:0xf bank_mask:0x3
s_nop 1
v_add_f32_dpp v48, v56, v56 row_ror:8 row_mask:0xf bank_mask:0xc
v_add_f32_dpp v49, v49, v49 row_ror:8 row_mask:0xf bank_mask:0x3
s_nop 1
v_add_f32_dpp v49, v57, v57 row_ror:8 row_mask:0xf bank_mask:0xc
v_add_f32_dpp v50, v50, v50 row_ror:8 row_mask:0xf bank_mask:0x3
s_nop 1
v_add_f32_dpp v50, v58, v58 row_ror:8 row_mask:0xf bank_mask:0xc
v_add_f32_dpp v51, v51, v51 row_ror:8 row_mask:0xf bank_mask:0x3
s_nop 1
v_add_f32_dpp v51, v59, v59 row_ror:8 row_mask:0xf bank_mask:0xc
v_add_f32_dpp v52, v52, v52 row_ror:8 row_mask:0xf bank_mask:0x3
s_nop 1
v_add_f32_dpp v52, v60, v60 row_ror:8 row_mask:0xf bank_mask:0xc
v_add_f32_dpp v53, v53, v53 row_ror:8 row_mask:0xf bank_mask:0x3
s_nop 1
v_add_f32_dpp v53, v61, v61 row_ror:8 row_mask:0xf bank_mask:0xc
v_add_f32_dpp v54, v54, v54 row_ror:8 row_mask:0xf bank_mask:0x3
s_nop 1
v_add_f32_dpp v54, v62, v62 row_ror:8 row_mask:0xf bank_mask:0xc
v_add_f32_dpp v55, v55, v55 row_ror:8 row_mask:0xf bank_mask:0x3
s_nop 1
v_add_f32_dpp v55, v63, v63 row_ror:8 row_mask:0xf bank_mask:0xc
v_add_f32_dpp v48, v48, v48 row_half_mirror row_mask:0xf bank_mask:0x5
s_nop 1
v_add_f32_dpp v48, v52, v52 row_half_mirror row_mask:0xf bank_mask:0xa
v_add_f32_dpp v49, v49, v49 row_half_mirror row_mask:0xf bank_mask:0x5
s_nop 1
v_add_f32_dpp v49, v53, v53 row_half_mirror row_mask:0xf bank_mask:0xa
v_add_f32_dpp v50, v50, v50 row_half_mirror row_mask:0xf bank_mask:0x5
s_nop 1
v_add_f32_dpp v50, v54, v54 row_half_mirror row_mask:0xf bank_mask:0xa
v_add_f32_dpp v51, v51, v51 row_half_mirror row_mask:0xf bank_mask:0x5
s_nop 1
v_add_f32_dpp v51, v55, v55 row_half_mirror row_mask:0xf bank_mask:0xa
v_cndmask_b32 v44, v48, v50, s[66:67]
v_cndmask_b32 v45, v50, v48, s[66:67]
v_cndmask_b32 v46, v49, v51, s[66:67]
v_cndmask_b32 v47, v51, v49, s[66:67]
v_add_f32_dpp v48, v45, v44 quad_perm:[2,3,0,1] row_mask:0xf bank_mask:0xf
s_nop 0
v_add_f32_dpp v49, v47, v46 quad_perm:[2,3,0,1] row_mask:0xf bank_mask:0xf
v_cndmask_b32 v44, v48, v49, s[68:69]
v_cndmask_b32 v45, v49, v48, s[68:69]
s_nop 1
v_add_f32_dpp v24, v45, v44 quad_perm:[1,0,3,2] row_mask:0xf bank_mask:0xf
v_dot2_f32_bf16 v48, v192, v40, 0
v_dot2_f32_bf16 v49, v196, v40, 0
v_dot2_f32_bf16 v48, v193, v41, v48
v_dot2_f32_bf16 v49, v197, v41, v49
v_dot2_f32_bf16 v48, v194, v42, v48
v_dot2_f32_bf16 v49, v198, v42, v49
v_dot2_f32_bf16 v48, v195, v43, v48
v_dot2_f32_bf16 v49, v199, v43, v49
s_waitcnt vmcnt(5)
s_add_u32 s65, s65, s43
buffer_load_dwordx4 v[192:195], v2, s[52:55], s65 offen offset:0 nt
s_waitcnt vmcnt(5)
buffer_load_dwordx4 v[196:199], v2, s[52:55], s65 offen offset:1024 nt
v_dot2_f32_bf16 v50, v200, v40, 0
v_dot2_f32_bf16 v51, v204, v40, 0
v_dot2_f32_bf16 v50, v201, v41, v50
v_dot2_f32_bf16 v51, v205, v41, v51
v_dot2_f32_bf16 v50, v202, v42, v50
v_dot2_f32_bf16 v51, v206, v42, v51
v_dot2_f32_bf16 v50, v203, v43, v50
v_dot2_f32_bf16 v51, v207, v43, v51
s_waitcnt vmcnt(5)
buffer_load_dwordx4 v[200:203], v2, s[52:55], s65 offen offset:2048 nt
s_waitcnt vmcnt(5)
buffer_load_dwordx4 v[204:207], v2, s[52:55], s65 offen offset:3072 nt
v_dot2_f32_bf16 v52, v208, v40, 0
v_dot2_f32_bf16 v53, v212, v40, 0
v_dot2_f32_bf16 v52, v209, v41, v52
v_dot2_f32_bf16 v53, v213, v41, v53
v_dot2_f32_bf16 v52, v210, v42, v52
v_dot2_f32_bf16 v53, v214, v42, v53
v_dot2_f32_bf16 v52, v211, v43, v52
v_dot2_f32_bf16 v53, v215, v43, v53
s_waitcnt vmcnt(5)
s_add_u32 s65, s65, s43
buffer_load_dwordx4 v[208:211], v2, s[52:55], s65 offen offset:0 nt
s_waitcnt vmcnt(5)
buffer_load_dwordx4 v[212:215], v2, s[52:55], s65 offen offset:1024 nt
v_dot2_f32_bf16 v54, v216, v40, 0
v_dot2_f32_bf16 v55, v220, v40, 0
v_dot2_f32_bf16 v54, v217, v41, v54
v_dot2_f32_bf16 v55, v221, v41, v55
v_dot2_f32_bf16 v54, v218, v42, v54
v_dot2_f32_bf16 v55, v222, v42, v55
v_dot2_f32_bf16 v54, v219, v43, v54
v_dot2_f32_bf16 v55, v223, v43, v55
s_waitcnt vmcnt(5)
buffer_load_dwordx4 v[216:219], v2, s[52:55], s65 offen offset:2048 nt
s_waitcnt vmcnt(5)
buffer_load_dwordx4 v[220:223], v2, s[52:55], s65 offen offset:3072 nt
v_dot2_f32_bf16 v56, v224, v40, 0
v_dot2_f32_bf16 v57, v228, v40, 0
v_dot2_f32_bf16 v56, v225, v41, v56
v_dot2_f32_bf16 v57, v229, v41, v57
v_dot2_f32_bf16 v56, v226, v42, v56
v_dot2_f32_bf16 v57, v230, v42, v57
v_dot2_f32_bf16 v56, v227, v43, v56
v_dot2_f32_bf16 v57, v231, v43, v57
s_waitcnt vmcnt(5)
s_add_u32 s65, s65, s43
buffer_load_dwordx4 v[224:227], v2, s[52:55], s65 offen offset:0 nt
s_waitcnt vmcnt(5)
buffer_load_dwordx4 v[228:231], v2, s[52:55], s65 offen offset:1024 nt
v_dot2_f32_bf16 v58, v232, v40, 0
v_dot2_f32_bf16 v59, v236, v40, 0
v_dot2_f32_bf16 v58, v233, v41, v58
v_dot2_f32_bf16 v59, v237, v41, v59
v_dot2_f32_bf16 v58, v234, v42, v58
v_dot2_f32_bf16 v59, v238, v42, v59
v_dot2_f32_bf16 v58, v235, v43, v58
v_dot2_f32_bf16 v59, v239, v43, v59
s_waitcnt vmcnt(5)
buffer_load_dwordx4 v[232:235], v2, s[52:55], s65 offen offset:2048 nt
s_waitcnt vmcnt(5)
buffer_load_dwordx4 v[236:239], v2, s[52:55], s65 offen offset:3072 nt
v_dot2_f32_bf16 v60, v240, v40, 0
v_dot2_f32_bf16 v61, v244, v40, 0
v_dot2_f32_bf16 v60, v241, v41, v60
v_dot2_f32_bf16 v61, v245, v41, v61
v_dot2_f32_bf16 v60, v242, v42, v60
v_dot2_f32_bf16 v61, v246, v42, v61
v_dot2_f32_bf16 v60, v243, v43, v60
v_dot2_f32_bf16 v61, v247, v43, v61
s_waitcnt vmcnt(5)
s_add_u32 s65, s65, s43
buffer_load_dwordx4 v[240:243], v2, s[52:55], s65 offen offset:0 nt
s_waitcnt vmcnt(5)
buffer_load_dwordx4 v[244:247], v2, s[52:55], s65 offen offset:1024 nt
v_dot2_f32_bf16 v62, v248, v40, 0
v_dot2_f32_bf16 v63, v252, v40, 0
v_dot2_f32_bf16 v62, v249, v41, v62
v_dot2_f32_bf16 v63, v253, v41, v63
v_dot2_f32_bf16 v62, v250, v42, v62
v_dot2_f32_bf16 v63, v254, v42, v63
v_dot2_f32_bf16 v62, v251, v43, v62
v_dot2_f32_bf16 v63, v255, v43, v63
s_waitcnt vmcnt(5)
buffer_load_dwordx4 v[248:251], v2, s[52:55], s65 offen offset:2048 nt
s_waitcnt vmcnt(5)
buffer_load_dwordx4 v[252:255], v2, s[52:55], s65 offen offset:3072 nt
v_add_f32_dpp v48, v48, v48 row_ror:8 row_mask:0xf bank_mask:0x3
s_nop 1
v_add_f32_dpp v48, v56, v56 row_ror:8 row_mask:0xf bank_mask:0xc
v_add_f32_dpp v49, v49, v49 row_ror:8 row_mask:0xf bank_mask:0x3
s_nop 1
v_add_f32_dpp v49, v57, v57 row_ror:8 row_mask:0xf bank_mask:0xc
v_add_f32_dpp v50, v50, v50 row_ror:8 row_mask:0xf bank_mask:0x3
s_nop 1
v_add_f32_dpp v50, v58, v58 row_ror:8 row_mask:0xf bank_mask:0xc
v_add_f32_dpp v51, v51, v51 row_ror:8 row_mask:0xf bank_mask:0x3
s_nop 1
v_add_f32_dpp v51, v59, v59 row_ror:8 row_mask:0xf bank_mask:0xc
v_add_f32_dpp v52, v52, v52 row_ror:8 row_mask:0xf bank_mask:0x3
s_nop 1
v_add_f32_dpp v52, v60, v60 row_ror:8 row_mask:0xf bank_mask:0xc
v_add_f32_dpp v53, v53, v53 row_ror:8 row_mask:0xf bank_mask:0x3
s_nop 1
v_add_f32_dpp v53, v61, v61 row_ror:8 row_mask:0xf bank_mask:0xc
v_add_f32_dpp v54, v54, v54 row_ror:8 row_mask:0xf bank_mask:0x3
s_nop 1
v_add_f32_dpp v54, v62, v62 row_ror:8 row_mask:0xf bank_mask:0xc
v_add_f32_dpp v55, v55, v55 row_ror:8 row_mask:0xf bank_mask:0x3
s_nop 1
v_add_f32_dpp v55, v63, v63 row_ror:8 row_mask:0xf bank_mask:0xc
v_add_f32_dpp v48, v48, v48 row_half_mirror row_mask:0xf bank_mask:0x5
s_nop 1
v_add_f32_dpp v48, v52, v52 row_half_mirror row_mask:0xf bank_mask:0xa
v_add_f32_dpp v49, v49, v49 row_half_mirror row_mask:0xf bank_mask:0x5
s_nop 1
v_add_f32_dpp v49, v53, v53 row_half_mirror row_mask:0xf bank_mask:0xa
v_add_f32_dpp v50, v50, v50 row_half_mirror row_mask:0xf bank_mask:0x5
s_nop 1
v_add_f32_dpp v50, v54, v54 row_half_mirror row_mask:0xf bank_mask:0xa
v_add_f32_dpp v51, v51, v51 row_half_mirror row_mask:0xf bank_mask:0x5
s_nop 1
v_add_f32_dpp v51, v55, v55 row_half_mirror row_mask:0xf bank_mask:0xa
v_cndmask_b32 v44, v48, v50, s[66:67]
v_cndmask_b32 v45, v50, v48, s[66:67]
v_cndmask_b32 v46, v49, v51, s[66:67]
v_cndmask_b32 v47, v51, v49, s[66:67]
v_add_f32_dpp v48, v45, v44 quad_perm:[2,3,0,1] row_mask:0xf bank_mask:0xf
s_nop 0
v_add_f32_dpp v49, v47, v46 quad_perm:[2,3,0,1] row_mask:0xf bank_mask:0xf
v_cndmask_b32 v44, v48, v49, s[68:69]
v_cndmask_b32 v45, v49, v48, s[68:69]
s_nop 1
v_add_f32_dpp v25, v45, v44 quad_perm:[1,0,3,2] row_mask:0xf bank_mask:0xf
v_dot2_f32_bf16 v48, v128, v40, 0
v_dot2_f32_bf16 v49, v132, v40, 0
v_dot2_f32_bf16 v48, v129, v41, v48
v_dot2_f32_bf16 v49, v133, v41, v49
v_dot2_f32_bf16 v48, v130, v42, v48
v_dot2_f32_bf16 v49, v134, v42, v49
v_dot2_f32_bf16 v48, v131, v43, v48
v_dot2_f32_bf16 v49, v135, v43, v49
s_waitcnt vmcnt(5)
s_add_u32 s65, s65, s43
buffer_load_dwordx4 v[128:131], v2, s[52:55], s65 offen offset:0 nt
s_waitcnt vmcnt(5)
buffer_load_dwordx4 v[132:135], v2, s[52:55], s65 offen offset:1024 nt
v_dot2_f32_bf16 v50, v136, v40, 0
v_dot2_f32_bf16 v51, v140, v40, 0
v_dot2_f32_bf16 v50, v137, v41, v50
v_dot2_f32_bf16 v51, v141, v41, v51
v_dot2_f32_bf16 v50, v138, v42, v50
v_dot2_f32_bf16 v51, v142, v42, v51
v_dot2_f32_bf16 v50, v139, v43, v50
v_dot2_f32_bf16 v51, v143, v43, v51
s_waitcnt vmcnt(5)
buffer_load_dwordx4 v[136:139], v2, s[52:55], s65 offen offset:2048 nt
s_waitcnt vmcnt(5)
buffer_load_dwordx4 v[140:143], v2, s[52:55], s65 offen offset:3072 nt
v_dot2_f32_bf16 v52, v144, v40, 0
v_dot2_f32_bf16 v53, v148, v40, 0
v_dot2_f32_bf16 v52, v145, v41, v52
v_dot2_f32_bf16 v53, v149, v41, v53
v_dot2_f32_bf16 v52, v146, v42, v52
v_dot2_f32_bf16 v53, v150, v42, v53
v_dot2_f32_bf16 v52, v147, v43, v52
v_dot2_f32_bf16 v53, v151, v43, v53
s_waitcnt vmcnt(5)
s_add_u32 s65, s65, s43
buffer_load_dwordx4 v[144:147], v2, s[52:55], s65 offen offset:0 nt
s_waitcnt vmcnt(5)
buffer_load_dwordx4 v[148:151], v2, s[52:55], s65 offen offset:1024 nt
v_dot2_f32_bf16 v54, v152, v40, 0
v_dot2_f32_bf16 v55, v156, v40, 0
v_dot2_f32_bf16 v54, v153, v41, v54
v_dot2_f32_bf16 v55, v157, v41, v55
v_dot2_f32_bf16 v54, v154, v42, v54
v_dot2_f32_bf16 v55, v158, v42, v55
v_dot2_f32_bf16 v54, v155, v43, v54
v_dot2_f32_bf16 v55, v159, v43, v55
s_waitcnt vmcnt(5)
buffer_load_dwordx4 v[152:155], v2, s[52:55], s65 offen offset:2048 nt
s_waitcnt vmcnt(5)
buffer_load_dwordx4 v[156:159], v2, s[52:55], s65 offen offset:3072 nt
v_dot2_f32_bf16 v56, v160, v40, 0
v_dot2_f32_bf16 v57, v164, v40, 0
v_dot2_f32_bf16 v56, v161, v41, v56
v_dot2_f32_bf16 v57, v165, v41, v57
v_dot2_f32_bf16 v56, v162, v42, v56
v_dot2_f32_bf16 v57, v166, v42, v57
v_dot2_f32_bf16 v56, v163, v43, v56
v_dot2_f32_bf16 v57, v167, v43, v57
s_waitcnt vmcnt(5)
s_add_u32 s65, s65, s43
buffer_load_dwordx4 v[160:163], v2, s[52:55], s65 offen offset:0 nt
s_waitcnt vmcnt(5)
buffer_load_dwordx4 v[164:167], v2, s[52:55], s65 offen offset:1024 nt
v_dot2_f32_bf16 v58, v168, v40, 0
v_dot2_f32_bf16 v59, v172, v40, 0
v_dot2_f32_bf16 v58, v169, v41, v58
v_dot2_f32_bf16 v59, v173, v41, v59
v_dot2_f32_bf16 v58, v170, v42, v58
v_dot2_f32_bf16 v59, v174, v42, v59
v_dot2_f32_bf16 v58, v171, v43, v58
v_dot2_f32_bf16 v59, v175, v43, v59
s_waitcnt vmcnt(5)
buffer_load_dwordx4 v[168:171], v2, s[52:55], s65 offen offset:2048 nt
s_waitcnt vmcnt(5)
buffer_load_dwordx4 v[172:175], v2, s[52:55], s65 offen offset:3072 nt
v_dot2_f32_bf16 v60, v176, v40, 0
v_dot2_f32_bf16 v61, v180, v40, 0
v_dot2_f32_bf16 v60, v177, v41, v60
v_dot2_f32_bf16 v61, v181, v41, v61
v_dot2_f32_bf16 v60, v178, v42, v60
v_dot2_f32_bf16 v61, v182, v42, v61
v_dot2_f32_bf16 v60, v179, v43, v60
v_dot2_f32_bf16 v61, v183, v43, v61
s_waitcnt vmcnt(5)
s_add_u32 s65, s65, s43
buffer_load_dwordx4 v[176:179], v2, s[52:55], s65 offen offset:0 nt
s_waitcnt vmcnt(5)
buffer_load_dwordx4 v[180:183], v2, s[52:55], s65 offen offset:1024 nt
v_dot2_f32_bf16 v62, v184, v40, 0
v_dot2_f32_bf16 v63, v188, v40, 0
v_dot2_f32_bf16 v62, v185, v41, v62
v_dot2_f32_bf16 v63, v189, v41, v63
v_dot2_f32_bf16 v62, v186, v42, v62
v_dot2_f32_bf16 v63, v190, v42, v63
v_dot2_f32_bf16 v62, v187, v43, v62
v_dot2_f32_bf16 v63, v191, v43, v63
s_waitcnt vmcnt(5)
buffer_load_dwordx4 v[184:187], v2, s[52:55], s65 offen offset:2048 nt
s_waitcnt vmcnt(5)
buffer_load_dwordx4 v[188:191], v2, s[52:55], s65 offen offset:3072 nt
v_add_f32_dpp v48, v48, v48 row_ror:8 row_mask:0xf bank_mask:0x3
s_nop 1
v_add_f32_dpp v48, v56, v56 row_ror:8 row_mask:0xf bank_mask:0xc
v_add_f32_dpp v49, v49, v49 row_ror:8 row_mask:0xf bank_mask:0x3
s_nop 1
v_add_f32_dpp v49, v57, v57 row_ror:8 row_mask:0xf bank_mask:0xc
v_add_f32_dpp v50, v50, v50 row_ror:8 row_mask:0xf bank_mask:0x3
s_nop 1
v_add_f32_dpp v50, v58, v58 row_ror:8 row_mask:0xf bank_mask:0xc
v_add_f32_dpp v51, v51, v51 row_ror:8 row_mask:0xf bank_mask:0x3
s_nop 1
v_add_f32_dpp v51, v59, v59 row_ror:8 row_mask:0xf bank_mask:0xc
v_add_f32_dpp v52, v52, v52 row_ror:8 row_mask:0xf bank_mask:0x3
s_nop 1
v_add_f32_dpp v52, v60, v60 row_ror:8 row_mask:0xf bank_mask:0xc
v_add_f32_dpp v53, v53, v53 row_ror:8 row_mask:0xf bank_mask:0x3
s_nop 1
v_add_f32_dpp v53, v61, v61 row_ror:8 row_mask:0xf bank_mask:0xc
v_add_f32_dpp v54, v54, v54 row_ror:8 row_mask:0xf bank_mask:0x3
s_nop 1
v_add_f32_dpp v54, v62, v62 row_ror:8 row_mask:0xf bank_mask:0xc
v_add_f32_dpp v55, v55, v55 row_ror:8 row_mask:0xf bank_mask:0x3
s_nop 1
v_add_f32_dpp v55, v63, v63 row_ror:8 row_mask:0xf bank_mask:0xc
v_add_f32_dpp v48, v48, v48 row_half_mirror row_mask:0xf bank_mask:0x5
s_nop 1
v_add_f32_dpp v48, v52, v52 row_half_mirror row_mask:0xf bank_mask:0xa
v_add_f32_dpp v49, v49, v49 row_half_mirror row_mask:0xf bank_mask:0x5
s_nop 1
v_add_f32_dpp v49, v53, v53 row_half_mirror row_mask:0xf bank_mask:0xa
v_add_f32_dpp v50, v50, v50 row_half_mirror row_mask:0xf bank_mask:0x5
s_nop 1
v_add_f32_dpp v50, v54, v54 row_half_mirror row_mask:0xf bank_mask:0xa
v_add_f32_dpp v51, v51, v51 row_half_mirror row_mask:0xf bank_mask:0x5
s_nop 1
v_add_f32_dpp v51, v55, v55 row_half_mirror row_mask:0xf bank_mask:0xa
v_cndmask_b32 v44, v48, v50, s[66:67]
v_cndmask_b32 v45, v50, v48, s[66:67]
v_cndmask_b32 v46, v49, v51, s[66:67]
v_cndmask_b32 v47, v51, v49, s[66:67]
v_add_f32_dpp v48, v45, v44 quad_perm:[2,3,0,1] row_mask:0xf bank_mask:0xf
s_nop 0
v_add_f32_dpp v49, v47, v46 quad_perm:[2,3,0,1] row_mask:0xf bank_mask:0xf
v_cndmask_b32 v44, v48, v49, s[68:69]
v_cndmask_b32 v45, v49, v48, s[68:69]
s_nop 1
v_add_f32_dpp v26, v45, v44 quad_perm:[1,0,3,2] row_mask:0xf bank_mask:0xf
v_dot2_f32_bf16 v48, v192, v40, 0
v_dot2_f32_bf16 v49, v196, v40, 0
v_dot2_f32_bf16 v48, v193, v41, v48
v_dot2_f32_bf16 v49, v197, v41, v49
v_dot2_f32_bf16 v48, v194, v42, v48
v_dot2_f32_bf16 v49, v198, v42, v49
v_dot2_f32_bf16 v48, v195, v43, v48
v_dot2_f32_bf16 v49, v199, v43, v49
s_waitcnt vmcnt(5)
s_add_u32 s65, s65, s43
buffer_load_dwordx4 v[192:195], v2, s[52:55], s65 offen offset:0 nt
s_waitcnt vmcnt(5)
buffer_load_dwordx4 v[196:199], v2, s[52:55], s65 offen offset:1024 nt
v_dot2_f32_bf16 v50, v200, v40, 0
v_dot2_f32_bf16 v51, v204, v40, 0
v_dot2_f32_bf16 v50, v201, v41, v50
v_dot2_f32_bf16 v51, v205, v41, v51
v_dot2_f32_bf16 v50, v202, v42, v50
v_dot2_f32_bf16 v51, v206, v42, v51
v_dot2_f32_bf16 v50, v203, v43, v50
v_dot2_f32_bf16 v51, v207, v43, v51
s_waitcnt vmcnt(5)
buffer_load_dwordx4 v[200:203], v2, s[52:55], s65 offen offset:2048 nt
s_waitcnt vmcnt(5)
buffer_load_dwordx4 v[204:207], v2, s[52:55], s65 offen offset:3072 nt
v_dot2_f32_bf16 v52, v208, v40, 0
v_dot2_f32_bf16 v53, v212, v40, 0
v_dot2_f32_bf16 v52, v209, v41, v52
v_dot2_f32_bf16 v53, v213, v41, v53
v_dot2_f32_bf16 v52, v210, v42, v52
v_dot2_f32_bf16 v53, v214, v42, v53
v_dot2_f32_bf16 v52, v211, v43, v52
v_dot2_f32_bf16 v53, v215, v43, v53
s_waitcnt vmcnt(5)
s_add_u32 s65, s65, s43
buffer_load_dwordx4 v[208:211], v2, s[52:55], s65 offen offset:0 nt
s_waitcnt vmcnt(5)
buffer_load_dwordx4 v[212:215], v2, s[52:55], s65 offen offset:1024 nt
v_dot2_f32_bf16 v54, v216, v40, 0
v_dot2_f32_bf16 v55, v220, v40, 0
v_dot2_f32_bf16 v54, v217, v41, v54
v_dot2_f32_bf16 v55, v221, v41, v55
v_dot2_f32_bf16 v54, v218, v42, v54
v_dot2_f32_bf16 v55, v222, v42, v55
v_dot2_f32_bf16 v54, v219, v43, v54
v_dot2_f32_bf16 v55, v223, v43, v55
s_waitcnt vmcnt(5)
buffer_load_dwordx4 v[216:219], v2, s[52:55], s65 offen offset:2048 nt
s_waitcnt vmcnt(5)
buffer_load_dwordx4 v[220:223], v2, s[52:55], s65 offen offset:3072 nt
v_dot2_f32_bf16 v56, v224, v40, 0
v_dot2_f32_bf16 v57, v228, v40, 0
v_dot2_f32_bf16 v56, v225, v41, v56
v_dot2_f32_bf16 v57, v229, v41, v57
v_dot2_f32_bf16 v56, v226, v42, v56
v_dot2_f32_bf16 v57, v230, v42, v57
v_dot2_f32_bf16 v56, v227, v43, v56
v_dot2_f32_bf16 v57, v231, v43, v57
s_waitcnt vmcnt(5)
s_add_u32 s65, s65, s43
buffer_load_dwordx4 v[224:227], v2, s[52:55], s65 offen offset:0 nt
s_waitcnt vmcnt(5)
buffer_load_dwordx4 v[228:231], v2, s[52:55], s65 offen offset:1024 nt
v_dot2_f32_bf16 v58, v232, v40, 0
v_dot2_f32_bf16 v59, v236, v40, 0
v_dot2_f32_bf16 v58, v233, v41, v58
v_dot2_f32_bf16 v59, v237, v41, v59
v_dot2_f32_bf16 v58, v234, v42, v58
v_dot2_f32_bf16 v59, v238, v42, v59
v_dot2_f32_bf16 v58, v235, v43, v58
v_dot2_f32_bf16 v59, v239, v43, v59
s_waitcnt vmcnt(5)
buffer_load_dwordx4 v[232:235], v2, s[52:55], s65 offen offset:2048 nt
s_waitcnt vmcnt(5)
buffer_load_dwordx4 v[236:239], v2, s[52:55], s65 offen offset:3072 nt
v_dot2_f32_bf16 v60, v240, v40, 0
v_dot2_f32_bf16 v61, v244, v40, 0
v_dot2_f32_bf16 v60, v241, v41, v60
v_dot2_f32_bf16 v61, v245, v41, v61
v_dot2_f32_bf16 v60, v242, v42, v60
v_dot2_f32_bf16 v61, v246, v42, v61
v_dot2_f32_bf16 v60, v243, v43, v60
v_dot2_f32_bf16 v61, v247, v43, v61
s_waitcnt vmcnt(5)
s_add_u32 s65, s65, s43
buffer_load_dwordx4 v[240:243], v2, s[52:55], s65 offen offset:0 nt
s_waitcnt vmcnt(5)
buffer_load_dwordx4 v[244:247], v2, s[52:55], s65 offen offset:1024 nt
v_dot2_f32_bf16 v62, v248, v40, 0
v_dot2_f32_bf16 v63, v252, v40, 0
v_dot2_f32_bf16 v62, v249, v41, v62
v_dot2_f32_bf16 v63, v253, v41, v63
v_dot2_f32_bf16 v62, v250, v42, v62
v_dot2_f32_bf16 v63, v254, v42, v63
v_dot2_f32_bf16 v62, v251, v43, v62
v_dot2_f32_bf16 v63, v255, v43, v63
s_waitcnt vmcnt(5)
buffer_load_dwordx4 v[248:251], v2, s[52:55], s65 offen offset:2048 nt
s_waitcnt vmcnt(5)
buffer_load_dwordx4 v[252:255], v2, s[52:55], s65 offen offset:3072 nt
v_add_f32_dpp v48, v48, v48 row_ror:8 row_mask:0xf bank_mask:0x3
s_nop 1
v_add_f32_dpp v48, v56, v56 row_ror:8 row_mask:0xf bank_mask:0xc
v_add_f32_dpp v49, v49, v49 row_ror:8 row_mask:0xf bank_mask:0x3
s_nop 1
v_add_f32_dpp v49, v57, v57 row_ror:8 row_mask:0xf bank_mask:0xc
v_add_f32_dpp v50, v50, v50 row_ror:8 row_mask:0xf bank_mask:0x3
s_nop 1
v_add_f32_dpp v50, v58, v58 row_ror:8 row_mask:0xf bank_mask:0xc
v_add_f32_dpp v51, v51, v51 row_ror:8 row_mask:0xf bank_mask:0x3
s_nop 1
v_add_f32_dpp v51, v59, v59 row_ror:8 row_mask:0xf bank_mask:0xc
v_add_f32_dpp v52, v52, v52 row_ror:8 row_mask:0xf bank_mask:0x3
s_nop 1
v_add_f32_dpp v52, v60, v60 row_ror:8 row_mask:0xf bank_mask:0xc
v_add_f32_dpp v53, v53, v53 row_ror:8 row_mask:0xf bank_mask:0x3
s_nop 1
v_add_f32_dpp v53, v61, v61 row_ror:8 row_mask:0xf bank_mask:0xc
v_add_f32_dpp v54, v54, v54 row_ror:8 row_mask:0xf bank_mask:0x3
s_nop 1
v_add_f32_dpp v54, v62, v62 row_ror:8 row_mask:0xf bank_mask:0xc
v_add_f32_dpp v55, v55, v55 row_ror:8 row_mask:0xf bank_mask:0x3
s_nop 1
v_add_f32_dpp v55, v63, v63 row_ror:8 row_mask:0xf bank_mask:0xc
v_add_f32_dpp v48, v48, v48 row_half_mirror row_mask:0xf bank_mask:0x5
s_nop 1
v_add_f32_dpp v48, v52, v52 row_half_mirror row_mask:0xf bank_mask:0xa
v_add_f32_dpp v49, v49, v49 row_half_mirror row_mask:0xf bank_mask:0x5
s_nop 1
v_add_f32_dpp v49, v53, v53 row_half_mirror row_mask:0xf bank_mask:0xa
v_add_f32_dpp v50, v50, v50 row_half_mirror row_mask:0xf bank_mask:0x5
s_nop 1
v_add_f32_dpp v50, v54, v54 row_half_mirror row_mask:0xf bank_mask:0xa
v_add_f32_dpp v51, v51, v51 row_half_mirror row_mask:0xf bank_mask:0x5
s_nop 1
v_add_f32_dpp v51, v55, v55 row_half_mirror row_mask:0xf bank_mask:0xa
v_cndmask_b32 v44, v48, v50, s[66:67]
v_cndmask_b32 v45, v50, v48, s[66:67]
v_cndmask_b32 v46, v49, v51, s[66:67]
v_cndmask_b32 v47, v51, v49, s[66:67]
v_add_f32_dpp v48, v45, v44 quad_perm:[2,3,0,1] row_mask:0xf bank_mask:0xf
s_nop 0
v_add_f32_dpp v49, v47, v46 quad_perm:[2,3,0,1] row_mask:0xf bank_mask:0xf
v_cndmask_b32 v44, v48, v49, s[68:69]
v_cndmask_b32 v45, v49, v48, s[68:69]
s_nop 1
v_add_f32_dpp v27, v45, v44 quad_perm:[1,0,3,2] row_mask:0xf bank_mask:0xf
s_mov_b64 exec, 1
ds_add_u32 v17, v19 offset:16
s_mov_b64 exec, -1
s_waitcnt lgkmcnt(0)
v_readfirstlane_b32 s76, v18
ds_read_b32 v18, v17 offset:20
v_dot2_f32_bf16 v48, v128, v40, 0
v_dot2_f32_bf16 v49, v132, v40, 0
v_dot2_f32_bf16 v48, v129, v41, v48
v_dot2_f32_bf16 v49, v133, v41, v49
v_dot2_f32_bf16 v48, v130, v42, v48
v_dot2_f32_bf16 v49, v134, v42, v49
v_dot2_f32_bf16 v48, v131, v43, v48
v_dot2_f32_bf16 v49, v135, v43, v49
s_cmp_lg_u32 s76, 0
s_cbranch_scc1 L_pc2
s_waitcnt vmcnt(4)
L_pc2:
s_add_u32 s65, s65, s43
buffer_load_dwordx4 v[128:131], v2, s[52:55], s65 offen offset:0 nt
s_cmp_lg_u32 s76, 0
s_cbranch_scc1 L_pc3
s_waitcnt vmcnt(4)
L_pc3:
s_waitcnt vmcnt(6)
buffer_load_dwordx4 v[132:135], v2, s[52:55], s65 offen offset:1024 nt
v_dot2_f32_bf16 v50, v136, v40, 0
v_dot2_f32_bf16 v51, v140, v40, 0
v_dot2_f32_bf16 v50, v137, v41, v50
v_dot2_f32_bf16 v51, v141, v41, v51
v_dot2_f32_bf16 v50, v138, v42, v50
v_dot2_f32_bf16 v51, v142, v42, v51
v_dot2_f32_bf16 v50, v139, v43, v50
v_dot2_f32_bf16 v51, v143, v43, v51
s_cmp_lg_u32 s76, 0
s_cbranch_scc1 L_pc4
s_waitcnt vmcnt(4)
L_pc4:
s_waitcnt vmcnt(6)
buffer_load_dwordx4 v[136:139], v2, s[52:55], s65 offen offset:2048 nt
s_cmp_lg_u32 s76, 0
s_cbranch_scc1 L_pc5
s_waitcnt vmcnt(4)
L_pc5:
s_waitcnt vmcnt(6)
buffer_load_dwordx4 v[140:143], v2, s[52:55], s65 offen offset:3072 nt
v_dot2_f32_bf16 v52, v144, v40, 0
v_dot2_f32_bf16 v53, v148, v40, 0
v_dot2_f32_bf16 v52, v145, v41, v52
v_dot2_f32_bf16 v53, v149, v41, v53
v_dot2_f32_bf16 v52, v146, v42, v52
v_dot2_f32_bf16 v53, v150, v42, v53
v_dot2_f32_bf16 v52, v147, v43, v52
v_dot2_f32_bf16 v53, v151, v43, v53
s_cmp_lg_u32 s76, 0
s_cbranch_scc1 L_pc6
s_waitcnt vmcnt(4)
L_pc6:
s_waitcnt vmcnt(6)
s_add_u32 s65, s65, s43
buffer_load_dwordx4 v[144:147], v2, s[52:55], s65 offen offset:0 nt
s_cmp_lg_u32 s76, 0
s_cbranch_scc1 L_pc7
s_waitcnt vmcnt(4)
L_pc7:
s_waitcnt vmcnt(6)
buffer_load_dwordx4 v[148:151], v2, s[52:55], s65 offen offset:1024 nt
v_dot2_f32_bf16 v54, v152, v40, 0
v_dot2_f32_bf16 v55, v156, v40, 0
v_dot2_f32_bf16 v54, v153, v41, v54
v_dot2_f32_bf16 v55, v157, v41, v55
v_dot2_f32_bf16 v54, v154, v42, v54
v_dot2_f32_bf16 v55, v158, v42, v55
v_dot2_f32_bf16 v54, v155, v43, v54
v_dot2_f32_bf16 v55, v159, v43, v55
s_cmp_lg_u32 s76, 0
s_cbranch_scc1 L_pc8
s_waitcnt vmcnt(4)
L_pc8:
s_waitcnt vmcnt(6)
buffer_load_dwordx4 v[152:155], v2, s[52:55], s65 offen offset:2048 nt
s_cmp_lg_u32 s76, 0
s_cbranch_scc1 L_pc9
s_waitcnt vmcnt(4)
L_pc9:
s_waitcnt vmcnt(6)
buffer_load_dwordx4 v[156:159], v2, s[52:55], s65 offen offset:3072 nt
s_waitcnt lgkmcnt(0)
v_readfirstlane_b32 s76, v18
ds_read_b32 v18, v17 offset:20
v_dot2_f32_bf16 v56, v160, v40, 0
v_dot2_f32_bf16 v57, v164, v40, 0
v_dot2_f32_bf16 v56, v161, v41, v56
v_dot2_f32_bf16 v57, v165, v41, v57
v_dot2_f32_bf16 v56, v162, v42, v56
v_dot2_f32_bf16 v57, v166, v42, v57
v_dot2_f32_bf16 v56, v163, v43, v56
v_dot2_f32_bf16 v57, v167, v43, v57
s_cmp_lg_u32 s76, 0
s_cbranch_scc1 L_pc10
s_waitcnt vmcnt(4)
L_pc10:
s_waitcnt vmcnt(6)
s_add_u32 s65, s65, s43
buffer_load_dwordx4 v[160:163], v2, s[52:55], s65 offen offset:0 nt
s_cmp_lg_u32 s76, 0
s_cbranch_scc1 L_pc11
s_waitcnt vmcnt(4)
L_pc11:
s_waitcnt vmcnt(6)
buffer_load_dwordx4 v[164:167], v2, s[52:55], s65 offen offset:1024 nt
v_dot2_f32_bf16 v58, v168, v40, 0
v_dot2_f32_bf16 v59, v172, v40, 0
v_dot2_f32_bf16 v58, v169, v41, v58
v_dot2_f32_bf16 v59, v173, v41, v59
v_dot2_f32_bf16 v58, v170, v42, v58
v_dot2_f32_bf16 v59, v174, v42, v59
v_dot2_f32_bf16 v58, v171, v43, v58
v_dot2_f32_bf16 v59, v175, v43, v59
s_cmp_lg_u32 s76, 0
s_cbranch_scc1 L_pc12
s_waitcnt vmcnt(4)
L_pc12:
s_waitcnt vmcnt(6)
buffer_load_dwordx4 v[168:171], v2, s[52:55], s65 offen offset:2048 nt
s_cmp_lg_u32 s76, 0
s_cbranch_scc1 L_pc13
s_waitcnt vmcnt(4)
L_pc13:
s_waitcnt vmcnt(6)
buffer_load_dwordx4 v[172:175], v2, s[52:55], s65 offen offset:3072 nt
v_dot2_f32_bf16 v60, v176, v40, 0
v_dot2_f32_bf16 v61, v180, v40, 0
v_dot2_f32_bf16 v60, v177, v41, v60
v_dot2_f32_bf16 v61, v181, v41, v61
v_dot2_f32_bf16 v60, v178, v42, v60
v_dot2_f32_bf16 v61, v182, v42, v61
v_dot2_f32_bf16 v60, v179, v43, v60
v_dot2_f32_bf16 v61, v183, v43, v61
s_cmp_lg_u32 s76, 0
s_cbranch_scc1 L_pc14
s_waitcnt vmcnt(4)
L_pc14:
s_waitcnt vmcnt(6)
s_add_u32 s65, s65, s43
buffer_load_dwordx4 v[176:179], v2, s[52:55], s65 offen offset:0 nt
s_cmp_lg_u32 s76, 0
s_cbranch_scc1 L_pc15
s_waitcnt vmcnt(4)
L_pc15:
s_waitcnt vmcnt(6)
buffer_load_dwordx4 v[180:183], v2, s[52:55], s65 offen offset:1024 nt
v_dot2_f32_bf16 v62, v184, v40, 0
v_dot2_f32_bf16 v63, v188, v40, 0
v_dot2_f32_bf16 v62, v185, v41, v62
v_dot2_f32_bf16 v63, v189, v41, v63
v_dot2_f32_bf16 v62, v186, v42, v62
v_dot2_f32_bf16 v63, v190, v42, v63
v_dot2_f32_bf16 v62, v187, v43, v62
v_dot2_f32_bf16 v63, v191, v43, v63
s_cmp_lg_u32 s76, 0
s_cbranch_scc1 L_pc16
s_waitcnt vmcnt(4)
L_pc16:
s_waitcnt vmcnt(6)
buffer_load_dwordx4 v[184:187], v2, s[52:55], s65 offen offset:2048 nt
s_cmp_lg_u32 s76, 0
s_cbranch_scc1 L_pc17
s_waitcnt vmcnt(4)
L_pc17:
s_waitcnt vmcnt(6)
buffer_load_dwordx4 v[188:191], v2, s[52:55], s65 offen offset:3072 nt
v_add_f32_dpp v48, v48, v48 row_ror:8 row_mask:0xf bank_mask:0x3
s_nop 1
v_add_f32_dpp v48, v56, v56 row_ror:8 row_mask:0xf bank_mask:0xc
v_add_f32_dpp v49, v49, v49 row_ror:8 row_mask:0xf bank_mask:0x3
s_nop 1
v_add_f32_dpp v49, v57, v57 row_ror:8 row_mask:0xf bank_mask:0xc
v_add_f32_dpp v50, v50, v50 row_ror:8 row_mask:0xf bank_mask:0x3
s_nop 1
v_add_f32_dpp v50, v58, v58 row_ror:8 row_mask:0xf bank_mask:0xc
v_add_f32_dpp v51, v51, v51 row_ror:8 row_mask:0xf bank_mask:0x3
s_nop 1
v_add_f32_dpp v51, v59, v59 row_ror:8 row_mask:0xf bank_mask:0xc
v_add_f32_dpp v52, v52, v52 row_ror:8 row_mask:0xf bank_mask:0x3
s_nop 1
v_add_f32_dpp v52, v60, v60 row_ror:8 row_mask:0xf bank_mask:0xc
v_add_f32_dpp v53, v53, v53 row_ror:8 row_mask:0xf bank_mask:0x3
s_nop 1
v_add_f32_dpp v53, v61, v61 row_ror:8 row_mask:0xf bank_mask:0xc
v_add_f32_dpp v54, v54, v54 row_ror:8 row_mask:0xf bank_mask:0x3
s_nop 1
v_add_f32_dpp v54, v62, v62 row_ror:8 row_mask:0xf bank_mask:0xc
v_add_f32_dpp v55, v55, v55 row_ror:8 row_mask:0xf bank_mask:0x3
s_nop 1
v_add_f32_dpp v55, v63, v63 row_ror:8 row_mask:0xf bank_mask:0xc
v_add_f32_dpp v48, v48, v48 row_half_mirror row_mask:0xf bank_mask:0x5
s_nop 1
v_add_f32_dpp v48, v52, v52 row_half_mirror row_mask:0xf bank_mask:0xa
v_add_f32_dpp v49, v49, v49 row_half_mirror row_mask:0xf bank_mask:0x5
s_nop 1
v_add_f32_dpp v49, v53, v53 row_half_mirror row_mask:0xf bank_mask:0xa
v_add_f32_dpp v50, v50, v50 row_half_mirror row_mask:0xf bank_mask:0x5
s_nop 1
v_add_f32_dpp v50, v54, v54 row_half_mirror row_mask:0xf bank_mask:0xa
v_add_f32_dpp v51, v51, v51 row_half_mirror row_mask:0xf bank_mask:0x5
s_nop 1
v_add_f32_dpp v51, v55, v55 row_half_mirror row_mask:0xf bank_mask:0xa
v_cndmask_b32 v44, v48, v50, s[66:67]
v_cndmask_b32 v45, v50, v48, s[66:67]
v_cndmask_b32 v46, v49, v51, s[66:67]
v_cndmask_b32 v47, v51, v49, s[66:67]
v_add_f32_dpp v48, v45, v44 quad_perm:[2,3,0,1] row_mask:0xf bank_mask:0xf
s_nop 0
v_add_f32_dpp v49, v47, v46 quad_perm:[2,3,0,1] row_mask:0xf bank_mask:0xf
v_cndmask_b32 v44, v48, v49, s[68:69]
v_cndmask_b32 v45, v49, v48, s[68:69]
s_nop 1
v_add_f32_dpp v28, v45, v44 quad_perm:[1,0,3,2] row_mask:0xf bank_mask:0xf
s_waitcnt lgkmcnt(0)
v_readfirstlane_b32 s76, v18
ds_read_b32 v18, v17 offset:20
v_dot2_f32_bf16 v48, v192, v40, 0
v_dot2_f32_bf16 v49, v196, v40, 0
v_dot2_f32_bf16 v48, v193, v41, v48
v_dot2_f32_bf16 v49, v197, v41, v49
v_dot2_f32_bf16 v48, v194, v42, v48
v_dot2_f32_bf16 v49, v198, v42, v49
v_dot2_f32_bf16 v48, v195, v43, v48
v_dot2_f32_bf16 v49, v199, v43, v49
s_cmp_lg_u32 s76, 0
s_cbranch_scc1 L_pc18
s_waitcnt vmcnt(4)
L_pc18:
s_waitcnt vmcnt(6)
s_add_u32 s65, s65, s43
buffer_load_dwordx4 v[192:195], v2, s[52:55], s65 offen offset:0 nt
s_cmp_lg_u32 s76, 0
s_cbranch_scc1 L_pc19
s_waitcnt vmcnt(4)
L_pc19:
s_waitcnt vmcnt(6)
buffer_load_dwordx4 v[196:199], v2, s[52:55], s65 offen offset:1024 nt
v_dot2_f32_bf16 v50, v200, v40, 0
v_dot2_f32_bf16 v51, v204, v40, 0
v_dot2_f32_bf16 v50, v201, v41, v50
v_dot2_f32_bf16 v51, v205, v41, v51
v_dot2_f32_bf16 v50, v202, v42, v50
v_dot2_f32_bf16 v51, v206, v42, v51
v_dot2_f32_bf16 v50, v203, v43, v50
v_dot2_f32_bf16 v51, v207, v43, v51
s_cmp_lg_u32 s76, 0
s_cbranch_scc1 L_pc20
s_waitcnt vmcnt(4)
L_pc20:
s_waitcnt vmcnt(6)
buffer_load_dwordx4 v[200:203], v2, s[52:55], s65 offen offset:2048 nt
s_cmp_lg_u32 s76, 0
s_cbranch_scc1 L_pc21
s_waitcnt vmcnt(4)
L_pc21:
s_waitcnt vmcnt(6)
buffer_load_dwordx4 v[204:207], v2, s[52:55], s65 offen offset:3072 nt
v_dot2_f32_bf16 v52, v208, v40, 0
v_dot2_f32_bf16 v53, v212, v40, 0
v_dot2_f32_bf16 v52, v209, v41, v52
v_dot2_f32_bf16 v53, v213, v41, v53
v_dot2_f32_bf16 v52, v210, v42, v52
v_dot2_f32_bf16 v53, v214, v42, v53
v_dot2_f32_bf16 v52, v211, v43, v52
v_dot2_f32_bf16 v53, v215, v43, v53
s_cmp_lg_u32 s76, 0
s_cbranch_scc1 L_pc22
s_waitcnt vmcnt(4)
L_pc22:
s_waitcnt vmcnt(6)
s_add_u32 s65, s65, s43
buffer_load_dwordx4 v[208:211], v2, s[52:55], s65 offen offset:0 nt
s_cmp_lg_u32 s76, 0
s_cbranch_scc1 L_pc23
s_waitcnt vmcnt(4)
L_pc23:
s_waitcnt vmcnt(6)
buffer_load_dwordx4 v[212:215], v2, s[52:55], s65 offen offset:1024 nt
v_dot2_f32_bf16 v54, v216, v40, 0
v_dot2_f32_bf16 v55, v220, v40, 0
v_dot2_f32_bf16 v54, v217, v41, v54
v_dot2_f32_bf16 v55, v221, v41, v55
v_dot2_f32_bf16 v54, v218, v42, v54
v_dot2_f32_bf16 v55, v222, v42, v55
v_dot2_f32_bf16 v54, v219, v43, v54
v_dot2_f32_bf16 v55, v223, v43, v55
s_cmp_lg_u32 s76, 0
s_cbranch_scc1 L_pc24
s_waitcnt vmcnt(4)
L_pc24:
s_waitcnt vmcnt(6)
buffer_load_dwordx4 v[216:219], v2, s[52:55], s65 offen offset:2048 nt
s_cmp_lg_u32 s76, 0
s_cbranch_scc1 L_pc25
s_waitcnt vmcnt(4)
L_pc25:
s_waitcnt vmcnt(6)
buffer_load_dwordx4 v[220:223], v2, s[52:55], s65 offen offset:3072 nt
s_waitcnt lgkmcnt(0)
v_readfirstlane_b32 s76, v18
ds_read_b32 v18, v17 offset:20
v_dot2_f32_bf16 v56, v224, v40, 0
v_dot2_f32_bf16 v57, v228, v40, 0
v_dot2_f32_bf16 v56, v225, v41, v56
v_dot2_f32_bf16 v57, v229, v41, v57
v_dot2_f32_bf16 v56, v226, v42, v56
v_dot2_f32_bf16 v57, v230, v42, v57
v_dot2_f32_bf16 v56, v227, v43, v56
v_dot2_f32_bf16 v57, v231, v43, v57
s_cmp_lg_u32 s76, 0
s_cbranch_scc1 L_pc26
s_waitcnt vmcnt(4)
L_pc26:
s_waitcnt vmcnt(6)
s_add_u32 s65, s65, s43
buffer_load_dwordx4 v[224:227], v2, s[52:55], s65 offen offset:0 nt
s_cmp_lg_u32 s76, 0
s_cbranch_scc1 L_pc27
s_waitcnt vmcnt(4)
L_pc27:
s_waitcnt vmcnt(6)
buffer_load_dwordx4 v[228:231], v2, s[52:55], s65 offen offset:1024 nt
v_dot2_f32_bf16 v58, v232, v40, 0
v_dot2_f32_bf16 v59, v236, v40, 0
v_dot2_f32_bf16 v58, v233, v41, v58
v_dot2_f32_bf16 v59, v237, v41, v59
v_dot2_f32_bf16 v58, v234, v42, v58
v_dot2_f32_bf16 v59, v238, v42, v59
v_dot2_f32_bf16 v58, v235, v43, v58
v_dot2_f32_bf16 v59, v239, v43, v59
s_cmp_lg_u32 s76, 0
s_cbranch_scc1 L_pc28
s_waitcnt vmcnt(4)
L_pc28:
s_waitcnt vmcnt(6)
buffer_load_dwordx4 v[232:235], v2, s[52:55], s65 offen offset:2048 nt
s_cmp_lg_u32 s76, 0
s_cbranch_scc1 L_pc29
s_waitcnt vmcnt(4)
L_pc29:
s_waitcnt vmcnt(6)
buffer_load_dwordx4 v[236:239], v2, s[52:55], s65 offen offset:3072 nt
v_dot2_f32_bf16 v60, v240, v40, 0
v_dot2_f32_bf16 v61, v244, v40, 0
v_dot2_f32_bf16 v60, v241, v41, v60
v_dot2_f32_bf16 v61, v245, v41, v61
v_dot2_f32_bf16 v60, v242, v42, v60
v_dot2_f32_bf16 v61, v246, v42, v61
v_dot2_f32_bf16 v60, v243, v43, v60
v_dot2_f32_bf16 v61, v247, v43, v61
s_cmp_lg_u32 s76, 0
s_cbranch_scc1 L_pc30
s_waitcnt vmcnt(4)
L_pc30:
s_waitcnt vmcnt(6)
s_add_u32 s65, s65, s43
buffer_load_dwordx4 v[240:243], v2, s[52:55], s65 offen offset:0 nt
s_cmp_lg_u32 s76, 0
s_cbranch_scc1 L_pc31
s_waitcnt vmcnt(4)
L_pc31:
s_waitcnt vmcnt(6)
buffer_load_dwordx4 v[244:247], v2, s[52:55], s65 offen offset:1024 nt
v_dot2_f32_bf16 v62, v248, v40, 0
v_dot2_f32_bf16 v63, v252, v40, 0
v_dot2_f32_bf16 v62, v249, v41, v62
v_dot2_f32_bf16 v63, v253, v41, v63
v_dot2_f32_bf16 v62, v250, v42, v62
v_dot2_f32_bf16 v63, v254, v42, v63
v_dot2_f32_bf16 v62, v251, v43, v62
v_dot2_f32_bf16 v63, v255, v43, v63
s_cmp_lg_u32 s76, 0
s_cbranch_scc1 L_pc32
s_waitcnt vmcnt(4)
L_pc32:
s_waitcnt vmcnt(6)
buffer_load_dwordx4 v[248:251], v2, s[52:55], s65 offen offset:2048 nt
s_cmp_lg_u32 s76, 0
s_cbranch_scc1 L_pc33
s_waitcnt vmcnt(4)
L_pc33:
s_waitcnt vmcnt(6)
buffer_load_dwordx4 v[252:255], v2, s[52:55], s65 offen offset:3072 nt
v_add_f32_dpp v48, v48, v48 row_ror:8 row_mask:0xf bank_mask:0x3
s_nop 1
v_add_f32_dpp v48, v56, v56 row_ror:8 row_mask:0xf bank_mask:0xc
v_add_f32_dpp v49, v49, v49 row_ror:8 row_mask:0xf bank_mask:0x3
s_nop 1
v_add_f32_dpp v49, v57, v57 row_ror:8 row_mask:0xf bank_mask:0xc
v_add_f32_dpp v50, v50, v50 row_ror:8 row_mask:0xf bank_mask:0x3
s_nop 1
v_add_f32_dpp v50, v58, v58 row_ror:8 row_mask:0xf bank_mask:0xc
v_add_f32_dpp v51, v51, v51 row_ror:8 row_mask:0xf bank_mask:0x3
s_nop 1
v_add_f32_dpp v51, v59, v59 row_ror:8 row_mask:0xf bank_mask:0xc
v_add_f32_dpp v52, v52, v52 row_ror:8 row_mask:0xf bank_mask:0x3
s_nop 1
v_add_f32_dpp v52, v60, v60 row_ror:8 row_mask:0xf bank_mask:0xc
v_add_f32_dpp v53, v53, v53 row_ror:8 row_mask:0xf bank_mask:0x3
s_nop 1
v_add_f32_dpp v53, v61, v61 row_ror:8 row_mask:0xf bank_mask:0xc
v_add_f32_dpp v54, v54, v54 row_ror:8 row_mask:0xf bank_mask:0x3
s_nop 1
v_add_f32_dpp v54, v62, v62 row_ror:8 row_mask:0xf bank_mask:0xc
v_add_f32_dpp v55, v55, v55 row_ror:8 row_mask:0xf bank_mask:0x3
s_nop 1
v_add_f32_dpp v55, v63, v63 row_ror:8 row_mask:0xf bank_mask:0xc
v_add_f32_dpp v48, v48, v48 row_half_mirror row_mask:0xf bank_mask:0x5
s_nop 1
v_add_f32_dpp v48, v52, v52 row_half_mirror row_mask:0xf bank_mask:0xa
v_add_f32_dpp v49, v49, v49 row_half_mirror row_mask:0xf bank_mask:0x5
s_nop 1
v_add_f32_dpp v49, v53, v53 row_half_mirror row_mask:0xf bank_mask:0xa
v_add_f32_dpp v50, v50, v50 row_half_mirror row_mask:0xf bank_mask:0x5
s_nop 1
v_add_f32_dpp v50, v54, v54 row_half_mirror row_mask:0xf bank_mask:0xa
v_add_f32_dpp v51, v51, v51 row_half_mirror row_mask:0xf bank_mask:0x5
s_nop 1
v_add_f32_dpp v51, v55, v55 row_half_mirror row_mask:0xf bank_mask:0xa
v_cndmask_b32 v44, v48, v50, s[66:67]
v_cndmask_b32 v45, v50, v48, s[66:67]
v_cndmask_b32 v46, v49, v51, s[66:67]
v_cndmask_b32 v47, v51, v49, s[66:67]
v_add_f32_dpp v48, v45, v44 quad_perm:[2,3,0,1] row_mask:0xf bank_mask:0xf
s_nop 0
v_add_f32_dpp v49, v47, v46 quad_perm:[2,3,0,1] row_mask:0xf bank_mask:0xf
v_cndmask_b32 v44, v48, v49, s[68:69]
v_cndmask_b32 v45, v49, v48, s[68:69]
s_nop 1
v_add_f32_dpp v29, v45, v44 quad_perm:[1,0,3,2] row_mask:0xf bank_mask:0xf
s_mov_b64 exec, 1
ds_add_u32 v17, v19 offset:16
s_mov_b64 exec, -1
s_waitcnt lgkmcnt(0)
v_readfirstlane_b32 s76, v18
ds_read_b32 v18, v17 offset:20
v_dot2_f32_bf16 v48, v128, v40, 0
v_dot2_f32_bf16 v49, v132, v40, 0
v_dot2_f32_bf16 v48, v129, v41, v48
v_dot2_f32_bf16 v49, v133, v41, v49
v_dot2_f32_bf16 v48, v130, v42, v48
v_dot2_f32_bf16 v49, v134, v42, v49
v_dot2_f32_bf16 v48, v131, v43, v48
v_dot2_f32_bf16 v49, v135, v43, v49
s_cmp_lg_u32 s76, 0
s_cbranch_scc1 L_pc34
s_waitcnt vmcnt(4)
L_pc34:
s_waitcnt vmcnt(6)
s_mov_b32 s65, s64
buffer_load_dwordx4 v[128:131], v2, s[56:59], s65 offen offset:0 nt
s_cmp_lg_u32 s76, 0
s_cbranch_scc1 L_pc35
s_waitcnt vmcnt(4)
L_pc35:
s_waitcnt vmcnt(6)
buffer_load_dwordx4 v[132:135], v2, s[56:59], s65 offen offset:1024 nt
v_dot2_f32_bf16 v50, v136, v40, 0
v_dot2_f32_bf16 v51, v140, v40, 0
v_dot2_f32_bf16 v50, v137, v41, v50
v_dot2_f32_bf16 v51, v141, v41, v51
v_dot2_f32_bf16 v50, v138, v42, v50
v_dot2_f32_bf16 v51, v142, v42, v51
v_dot2_f32_bf16 v50, v139, v43, v50
v_dot2_f32_bf16 v51, v143, v43, v51
s_cmp_lg_u32 s76, 0
s_cbranch_scc1 L_pc36
s_waitcnt vmcnt(4)
L_pc36:
s_waitcnt vmcnt(6)
buffer_load_dwordx4 v[136:139], v2, s[56:59], s65 offen offset:2048 nt
s_cmp_lg_u32 s76, 0
s_cbranch_scc1 L_pc37
s_waitcnt vmcnt(4)
L_pc37:
s_waitcnt vmcnt(6)
buffer_load_dwordx4 v[140:143], v2, s[56:59], s65 offen offset:3072 nt
v_dot2_f32_bf16 v52, v144, v40, 0
v_dot2_f32_bf16 v53, v148, v40, 0
v_dot2_f32_bf16 v52, v145, v41, v52
v_dot2_f32_bf16 v53, v149, v41, v53
v_dot2_f32_bf16 v52, v146, v42, v52
v_dot2_f32_bf16 v53, v150, v42, v53
v_dot2_f32_bf16 v52, v147, v43, v52
v_dot2_f32_bf16 v53, v151, v43, v53
s_cmp_lg_u32 s76, 0
s_cbranch_scc1 L_pc38
s_waitcnt vmcnt(4)
L_pc38:
s_waitcnt vmcnt(6)
s_add_u32 s65, s65, s43
buffer_load_dwordx4 v[144:147], v2, s[56:59], s65 offen offset:0 nt
s_cmp_lg_u32 s76, 0
s_cbranch_scc1 L_pc39
s_waitcnt vmcnt(4)
L_pc39:
s_waitcnt vmcnt(6)
buffer_load_dwordx4 v[148:151], v2, s[56:59], s65 offen offset:1024 nt
v_dot2_f32_bf16 v54, v152, v40, 0
v_dot2_f32_bf16 v55, v156, v40, 0
v_dot2_f32_bf16 v54, v153, v41, v54
v_dot2_f32_bf16 v55, v157, v41, v55
v_dot2_f32_bf16 v54, v154, v42, v54
v_dot2_f32_bf16 v55, v158, v42, v55
v_dot2_f32_bf16 v54, v155, v43, v54
v_dot2_f32_bf16 v55, v159, v43, v55
s_cmp_lg_u32 s76, 0
s_cbranch_scc1 L_pc40
s_waitcnt vmcnt(4)
L_pc40:
s_waitcnt vmcnt(6)
buffer_load_dwordx4 v[152:155], v2, s[56:59], s65 offen offset:2048 nt
s_cmp_lg_u32 s76, 0
s_cbranch_scc1 L_pc41
s_waitcnt vmcnt(4)
L_pc41:
s_waitcnt vmcnt(6)
buffer_load_dwordx4 v[156:159], v2, s[56:59], s65 offen offset:3072 nt
s_waitcnt lgkmcnt(0)
v_readfirstlane_b32 s76, v18
ds_read_b32 v18, v17 offset:20
v_dot2_f32_bf16 v56, v160, v40, 0
v_dot2_f32_bf16 v57, v164, v40, 0
v_dot2_f32_bf16 v56, v161, v41, v56
v_dot2_f32_bf16 v57, v165, v41, v57
v_dot2_f32_bf16 v56, v162, v42, v56
v_dot2_f32_bf16 v57, v166, v42, v57
v_dot2_f32_bf16 v56, v163, v43, v56
v_dot2_f32_bf16 v57, v167, v43, v57
s_cmp_lg_u32 s76, 0
s_cbranch_scc1 L_pc42
s_waitcnt vmcnt(4)
L_pc42:
s_waitcnt vmcnt(6)
s_add_u32 s65, s65, s43
buffer_load_dwordx4 v[160:163], v2, s[56:59], s65 offen offset:0 nt
s_cmp_lg_u32 s76, 0
s_cbranch_scc1 L_pc43
s_waitcnt vmcnt(4)
L_pc43:
s_waitcnt vmcnt(6)
buffer_load_dwordx4 v[164:167], v2, s[56:59], s65 offen offset:1024 nt
v_dot2_f32_bf16 v58, v168, v40, 0
v_dot2_f32_bf16 v59, v172, v40, 0
v_dot2_f32_bf16 v58, v169, v41, v58
v_dot2_f32_bf16 v59, v173, v41, v59
v_dot2_f32_bf16 v58, v170, v42, v58
v_dot2_f32_bf16 v59, v174, v42, v59
v_dot2_f32_bf16 v58, v171, v43, v58
v_dot2_f32_bf16 v59, v175, v43, v59
s_cmp_lg_u32 s76, 0
s_cbranch_scc1 L_pc44
s_waitcnt vmcnt(4)
L_pc44:
s_waitcnt vmcnt(6)
buffer_load_dwordx4 v[168:171], v2, s[56:59], s65 offen offset:2048 nt
s_cmp_lg_u32 s76, 0
s_cbranch_scc1 L_pc45
s_waitcnt vmcnt(4)
L_pc45:
s_waitcnt vmcnt(6)
buffer_load_dwordx4 v[172:175], v2, s[56:59], s65 offen offset:3072 nt
v_dot2_f32_bf16 v60, v176, v40, 0
v_dot2_f32_bf16 v61, v180, v40, 0
v_dot2_f32_bf16 v60, v177, v41, v60
v_dot2_f32_bf16 v61, v181, v41, v61
v_dot2_f32_bf16 v60, v178, v42, v60
v_dot2_f32_bf16 v61, v182, v42, v61
v_dot2_f32_bf16 v60, v179, v43, v60
v_dot2_f32_bf16 v61, v183, v43, v61
s_cmp_lg_u32 s76, 0
s_cbranch_scc1 L_pc46
s_waitcnt vmcnt(4)
L_pc46:
s_waitcnt vmcnt(6)
s_add_u32 s65, s65, s43
buffer_load_dwordx4 v[176:179], v2, s[56:59], s65 offen offset:0 nt
s_cmp_lg_u32 s76, 0
s_cbranch_scc1 L_pc47
s_waitcnt vmcnt(4)
L_pc47:
s_waitcnt vmcnt(6)
buffer_load_dwordx4 v[180:183], v2, s[56:59], s65 offen offset:1024 nt
v_dot2_f32_bf16 v62, v184, v40, 0
v_dot2_f32_bf16 v63, v188, v40, 0
v_dot2_f32_bf16 v62, v185, v41, v62
v_dot2_f32_bf16 v63, v189, v41, v63
v_dot2_f32_bf16 v62, v186, v42, v62
v_dot2_f32_bf16 v63, v190, v42, v63
v_dot2_f32_bf16 v62, v187, v43, v62
v_dot2_f32_bf16 v63, v191, v43, v63
s_cmp_lg_u32 s76, 0
s_cbranch_scc1 L_pc48
s_waitcnt vmcnt(4)
L_pc48:
s_waitcnt vmcnt(6)
buffer_load_dwordx4 v[184:187], v2, s[56:59], s65 offen offset:2048 nt
s_cmp_lg_u32 s76, 0
s_cbranch_scc1 L_pc49
s_waitcnt vmcnt(4)
L_pc49:
s_waitcnt vmcnt(6)
buffer_load_dwordx4 v[188:191], v2, s[56:59], s65 offen offset:3072 nt
v_add_f32_dpp v48, v48, v48 row_ror:8 row_mask:0xf bank_mask:0x3
s_nop 1
v_add_f32_dpp v48, v56, v56 row_ror:8 row_mask:0xf bank_mask:0xc
v_add_f32_dpp v49, v49, v49 row_ror:8 row_mask:0xf bank_mask:0x3
s_nop 1
v_add_f32_dpp v49, v57, v57 row_ror:8 row_mask:0xf bank_mask:0xc
v_add_f32_dpp v50, v50, v50 row_ror:8 row_mask:0xf bank_mask:0x3
s_nop 1
v_add_f32_dpp v50, v58, v58 row_ror:8 row_mask:0xf bank_mask:0xc
v_add_f32_dpp v51, v51, v51 row_ror:8 row_mask:0xf bank_mask:0x3
s_nop 1
v_add_f32_dpp v51, v59, v59 row_ror:8 row_mask:0xf bank_mask:0xc
v_add_f32_dpp v52, v52, v52 row_ror:8 row_mask:0xf bank_mask:0x3
s_nop 1
v_add_f32_dpp v52, v60, v60 row_ror:8 row_mask:0xf bank_mask:0xc
v_add_f32_dpp v53, v53, v53 row_ror:8 row_mask:0xf bank_mask:0x3
s_nop 1
v_add_f32_dpp v53, v61, v61 row_ror:8 row_mask:0xf bank_mask:0xc
v_add_f32_dpp v54, v54, v54 row_ror:8 row_mask:0xf bank_mask:0x3
s_nop 1
v_add_f32_dpp v54, v62, v62 row_ror:8 row_mask:0xf bank_mask:0xc
v_add_f32_dpp v55, v55, v55 row_ror:8 row_mask:0xf bank_mask:0x3
s_nop 1
v_add_f32_dpp v55, v63, v63 row_ror:8 row_mask:0xf bank_mask:0xc
v_add_f32_dpp v48, v48, v48 row_half_mirror row_mask:0xf bank_mask:0x5
s_nop 1
v_add_f32_dpp v48, v52, v52 row_half_mirror row_mask:0xf bank_mask:0xa
v_add_f32_dpp v49, v49, v49 row_half_mirror row_mask:0xf bank_mask:0x5
s_nop 1
v_add_f32_dpp v49, v53, v53 row_half_mirror row_mask:0xf bank_mask:0xa
v_add_f32_dpp v50, v50, v50 row_half_mirror row_mask:0xf bank_mask:0x5
s_nop 1
v_add_f32_dpp v50, v54, v54 row_half_mirror row_mask:0xf bank_mask:0xa
v_add_f32_dpp v51, v51, v51 row_half_mirror row_mask:0xf bank_mask:0x5
s_nop 1
v_add_f32_dpp v51, v55, v55 row_half_mirror row_mask:0xf bank_mask:0xa
v_cndmask_b32 v44, v48, v50, s[66:67]
v_cndmask_b32 v45, v50, v48, s[66:67]
v_cndmask_b32 v46, v49, v51, s[66:67]
v_cndmask_b32 v47, v51, v49, s[66:67]
v_add_f32_dpp v48, v45, v44 quad_perm:[2,3,0,1] row_mask:0xf bank_mask:0xf
s_nop 0
v_add_f32_dpp v49, v47, v46 quad_perm:[2,3,0,1] row_mask:0xf bank_mask:0xf
v_cndmask_b32 v44, v48, v49, s[68:69]
v_cndmask_b32 v45, v49, v48, s[68:69]
s_nop 1
v_add_f32_dpp v30, v45, v44 quad_perm:[1,0,3,2] row_mask:0xf bank_mask:0xf
s_waitcnt lgkmcnt(0)
v_readfirstlane_b32 s76, v18
ds_read_b32 v18, v17 offset:20
v_dot2_f32_bf16 v48, v192, v40, 0
v_dot2_f32_bf16 v49, v196, v40, 0
v_dot2_f32_bf16 v48, v193, v41, v48
v_dot2_f32_bf16 v49, v197, v41, v49
v_dot2_f32_bf16 v48, v194, v42, v48
v_dot2_f32_bf16 v49, v198, v42, v49
v_dot2_f32_bf16 v48, v195, v43, v48
v_dot2_f32_bf16 v49, v199, v43, v49
s_cmp_lg_u32 s76, 0
s_cbranch_scc1 L_pc50
s_waitcnt vmcnt(4)
L_pc50:
s_waitcnt vmcnt(6)
s_add_u32 s65, s65, s43
buffer_load_dwordx4 v[192:195], v2, s[56:59], s65 offen offset:0 nt
s_cmp_lg_u32 s76, 0
s_cbranch_scc1 L_pc51
s_waitcnt vmcnt(4)
L_pc51:
s_waitcnt vmcnt(6)
buffer_load_dwordx4 v[196:199], v2, s[56:59], s65 offen offset:1024 nt
v_dot2_f32_bf16 v50, v200, v40, 0
v_dot2_f32_bf16 v51, v204, v40, 0
v_dot2_f32_bf16 v50, v201, v41, v50
v_dot2_f32_bf16 v51, v205, v41, v51
v_dot2_f32_bf16 v50, v202, v42, v50
v_dot2_f32_bf16 v51, v206, v42, v51
v_dot2_f32_bf16 v50, v203, v43, v50
v_dot2_f32_bf16 v51, v207, v43, v51
s_cmp_lg_u32 s76, 0
s_cbranch_scc1 L_pc52
s_waitcnt vmcnt(4)
L_pc52:
s_waitcnt vmcnt(6)
buffer_load_dwordx4 v[200:203], v2, s[56:59], s65 offen offset:2048 nt
s_cmp_lg_u32 s76, 0
s_cbranch_scc1 L_pc53
s_waitcnt vmcnt(4)
L_pc53:
s_waitcnt vmcnt(6)
buffer_load_dwordx4 v[204:207], v2, s[56:59], s65 offen offset:3072 nt
v_dot2_f32_bf16 v52, v208, v40, 0
v_dot2_f32_bf16 v53, v212, v40, 0
v_dot2_f32_bf16 v52, v209, v41, v52
v_dot2_f32_bf16 v53, v213, v41, v53
v_dot2_f32_bf16 v52, v210, v42, v52
v_dot2_f32_bf16 v53, v214, v42, v53
v_dot2_f32_bf16 v52, v211, v43, v52
v_dot2_f32_bf16 v53, v215, v43, v53
s_cmp_lg_u32 s76, 0
s_cbranch_scc1 L_pc54
s_waitcnt vmcnt(4)
L_pc54:
s_waitcnt vmcnt(6)
s_add_u32 s65, s65, s43
buffer_load_dwordx4 v[208:211], v2, s[56:59], s65 offen offset:0 nt
s_cmp_lg_u32 s76, 0
s_cbranch_scc1 L_pc55
s_waitcnt vmcnt(4)
L_pc55:
s_waitcnt vmcnt(6)
buffer_load_dwordx4 v[212:215], v2, s[56:59], s65 offen offset:1024 nt
v_dot2_f32_bf16 v54, v216, v40, 0
v_dot2_f32_bf16 v55, v220, v40, 0
v_dot2_f32_bf16 v54, v217, v41, v54
v_dot2_f32_bf16 v55, v221, v41, v55
v_dot2_f32_bf16 v54, v218, v42, v54
v_dot2_f32_bf16 v55, v222, v42, v55
v_dot2_f32_bf16 v54, v219, v43, v54
v_dot2_f32_bf16 v55, v223, v43, v55
s_cmp_lg_u32 s76, 0
s_cbranch_scc1 L_pc56
s_waitcnt vmcnt(4)
L_pc56:
s_waitcnt vmcnt(6)
buffer_load_dwordx4 v[216:219], v2, s[56:59], s65 offen offset:2048 nt
s_cmp_lg_u32 s76, 0
s_cbranch_scc1 L_pc57
s_waitcnt vmcnt(4)
L_pc57:
s_waitcnt vmcnt(6)
buffer_load_dwordx4 v[220:223], v2, s[56:59], s65 offen offset:3072 nt
s_waitcnt lgkmcnt(0)
v_readfirstlane_b32 s76, v18
ds_read_b32 v18, v17 offset:20
v_dot2_f32_bf16 v56, v224, v40, 0
v_dot2_f32_bf16 v57, v228, v40, 0
v_dot2_f32_bf16 v56, v225, v41, v56
v_dot2_f32_bf16 v57, v229, v41, v57
v_dot2_f32_bf16 v56, v226, v42, v56
v_dot2_f32_bf16 v57, v230, v42, v57
v_dot2_f32_bf16 v56, v227, v43, v56
v_dot2_f32_bf16 v57, v231, v43, v57
s_cmp_lg_u32 s76, 0
s_cbranch_scc1 L_pc58
s_waitcnt vmcnt(4)
L_pc58:
s_waitcnt vmcnt(6)
s_add_u32 s65, s65, s43
buffer_load_dwordx4 v[224:227], v2, s[56:59], s65 offen offset:0 nt
s_cmp_lg_u32 s76, 0
s_cbranch_scc1 L_pc59
s_waitcnt vmcnt(4)
L_pc59:
s_waitcnt vmcnt(6)
buffer_load_dwordx4 v[228:231], v2, s[56:59], s65 offen offset:1024 nt
v_dot2_f32_bf16 v58, v232, v40, 0
v_dot2_f32_bf16 v59, v236, v40, 0
v_dot2_f32_bf16 v58, v233, v41, v58
v_dot2_f32_bf16 v59, v237, v41, v59
v_dot2_f32_bf16 v58, v234, v42, v58
v_dot2_f32_bf16 v59, v238, v42, v59
v_dot2_f32_bf16 v58, v235, v43, v58
v_dot2_f32_bf16 v59, v239, v43, v59
s_cmp_lg_u32 s76, 0
s_cbranch_scc1 L_pc60
s_waitcnt vmcnt(4)
L_pc60:
s_waitcnt vmcnt(6)
buffer_load_dwordx4 v[232:235], v2, s[56:59], s65 offen offset:2048 nt
s_cmp_lg_u32 s76, 0
s_cbranch_scc1 L_pc61
s_waitcnt vmcnt(4)
L_pc61:
s_waitcnt vmcnt(6)
buffer_load_dwordx4 v[236:239], v2, s[56:59], s65 offen offset:3072 nt
v_dot2_f32_bf16 v60, v240, v40, 0
v_dot2_f32_bf16 v61, v244, v40, 0
v_dot2_f32_bf16 v60, v241, v41, v60
v_dot2_f32_bf16 v61, v245, v41, v61
v_dot2_f32_bf16 v60, v242, v42, v60
v_dot2_f32_bf16 v61, v246, v42, v61
v_dot2_f32_bf16 v60, v243, v43, v60
v_dot2_f32_bf16 v61, v247, v43, v61
s_cmp_lg_u32 s76, 0
s_cbranch_scc1 L_pc62
s_waitcnt vmcnt(4)
L_pc62:
s_waitcnt vmcnt(6)
s_add_u32 s65, s65, s43
buffer_load_dwordx4 v[240:243], v2, s[56:59], s65 offen offset:0 nt
s_cmp_lg_u32 s76, 0
s_cbranch_scc1 L_pc63
s_waitcnt vmcnt(4)
L_pc63:
s_waitcnt vmcnt(6)
buffer_load_dwordx4 v[244:247], v2, s[56:59], s65 offen offset:1024 nt
v_dot2_f32_bf16 v62, v248, v40, 0
v_dot2_f32_bf16 v63, v252, v40, 0
v_dot2_f32_bf16 v62, v249, v41, v62
v_dot2_f32_bf16 v63, v253, v41, v63
v_dot2_f32_bf16 v62, v250, v42, v62
v_dot2_f32_bf16 v63, v254, v42, v63
v_dot2_f32_bf16 v62, v251, v43, v62
v_dot2_f32_bf16 v63, v255, v43, v63
s_cmp_lg_u32 s76, 0
s_cbranch_scc1 L_pc64
s_waitcnt vmcnt(4)
L_pc64:
s_waitcnt vmcnt(6)
buffer_load_dwordx4 v[248:251], v2, s[56:59], s65 offen offset:2048 nt
s_cmp_lg_u32 s76, 0
s_cbranch_scc1 L_pc65
s_waitcnt vmcnt(4)
L_pc65:
s_waitcnt vmcnt(6)
buffer_load_dwordx4 v[252:255], v2, s[56:59], s65 offen offset:3072 nt
v_add_f32_dpp v48, v48, v48 row_ror:8 row_mask:0xf bank_mask:0x3
s_nop 1
v_add_f32_dpp v48, v56, v56 row_ror:8 row_mask:0xf bank_mask:0xc
v_add_f32_dpp v49, v49, v49 row_ror:8 row_mask:0xf bank_mask:0x3
s_nop 1
v_add_f32_dpp v49, v57, v57 row_ror:8 row_mask:0xf bank_mask:0xc
v_add_f32_dpp v50, v50, v50 row_ror:8 row_mask:0xf bank_mask:0x3
s_nop 1
v_add_f32_dpp v50, v58, v58 row_ror:8 row_mask:0xf bank_mask:0xc
v_add_f32_dpp v51, v51, v51 row_ror:8 row_mask:0xf bank_mask:0x3
s_nop 1
v_add_f32_dpp v51, v59, v59 row_ror:8 row_mask:0xf bank_mask:0xc
v_add_f32_dpp v52, v52, v52 row_ror:8 row_mask:0xf bank_mask:0x3
s_nop 1
v_add_f32_dpp v52, v60, v60 row_ror:8 row_mask:0xf bank_mask:0xc
v_add_f32_dpp v53, v53, v53 row_ror:8 row_mask:0xf bank_mask:0x3
s_nop 1
v_add_f32_dpp v53, v61, v61 row_ror:8 row_mask:0xf bank_mask:0xc
v_add_f32_dpp v54, v54, v54 row_ror:8 row_mask:0xf bank_mask:0x3
s_nop 1
v_add_f32_dpp v54, v62, v62 row_ror:8 row_mask:0xf bank_mask:0xc
v_add_f32_dpp v55, v55, v55 row_ror:8 row_mask:0xf bank_mask:0x3
s_nop 1
v_add_f32_dpp v55, v63, v63 row_ror:8 row_mask:0xf bank_mask:0xc
v_add_f32_dpp v48, v48, v48 row_half_mirror row_mask:0xf bank_mask:0x5
s_nop 1
v_add_f32_dpp v48, v52, v52 row_half_mirror row_mask:0xf bank_mask:0xa
v_add_f32_dpp v49, v49, v49 row_half_mirror row_mask:0xf bank_mask:0x5
s_nop 1
v_add_f32_dpp v49, v53, v53 row_half_mirror row_mask:0xf bank_mask:0xa
v_add_f32_dpp v50, v50, v50 row_half_mirror row_mask:0xf bank_mask:0x5
s_nop 1
v_add_f32_dpp v50, v54, v54 row_half_mirror row_mask:0xf bank_mask:0xa
v_add_f32_dpp v51, v51, v51 row_half_mirror row_mask:0xf bank_mask:0x5
s_nop 1
v_add_f32_dpp v51, v55, v55 row_half_mirror row_mask:0xf bank_mask:0xa
v_cndmask_b32 v44, v48, v50, s[66:67]
v_cndmask_b32 v45, v50, v48, s[66:67]
v_cndmask_b32 v46, v49, v51, s[66:67]
v_cndmask_b32 v47, v51, v49, s[66:67]
v_add_f32_dpp v48, v45, v44 quad_perm:[2,3,0,1] row_mask:0xf bank_mask:0xf
s_nop 0
v_add_f32_dpp v49, v47, v46 quad_perm:[2,3,0,1] row_mask:0xf bank_mask:0xf
v_cndmask_b32 v44, v48, v49, s[68:69]
v_cndmask_b32 v45, v49, v48, s[68:69]
s_nop 1
v_add_f32_dpp v31, v45, v44 quad_perm:[1,0,3,2] row_mask:0xf bank_mask:0xf
s_mov_b64 exec, 1
ds_add_u32 v17, v19 offset:16
s_mov_b64 exec, -1
s_waitcnt lgkmcnt(0)
v_readfirstlane_b32 s76, v18
ds_read_b32 v18, v17 offset:20
v_max3_f32 v44, v24, v25, v26
v_max3_f32 v44, v44, v27, v28
v_max3_f32 v44, v44, v29, v30
v_max_f32 v44, v44, v31
s_nop 1
v_max_f32_dpp v44, v44, v44 row_ror:8 row_mask:0xf bank_mask:0xf
s_nop 1
v_max_f32_dpp v44, v44, v44 row_ror:4 row_mask:0xf bank_mask:0xf
s_nop 1
v_max_f32_dpp v44, v44, v44 quad_perm:[2,3,0,1] row_mask:0xf bank_mask:0xf
s_nop 1
v_max_f32_dpp v44, v44, v44 quad_perm:[1,0,3,2] row_mask:0xf bank_mask:0xf
s_nop 0
v_readlane_b32 s8, v44, 0
v_readlane_b32 s9, v44, 16
v_readlane_b32 s10, v44, 32
v_readlane_b32 s11, v44, 48
v_mov_b32 v44, s8
v_max_f32 v44, s9, v44
v_max_f32 v44, s10, v44
v_max_f32 v44, s11, v44
v_mul_f32 v46, s42, v44
v_fma_f32 v24, v24, s42, -v46
v_fma_f32 v25, v25, s42, -v46
v_fma_f32 v26, v26, s42, -v46
v_fma_f32 v27, v27, s42, -v46
v_fma_f32 v28, v28, s42, -v46
v_fma_f32 v29, v29, s42, -v46
v_fma_f32 v30, v30, s42, -v46
v_fma_f32 v31, v31, s42, -v46
v_exp_f32 v24, v24
v_exp_f32 v25, v25
v_exp_f32 v26, v26
v_exp_f32 v27, v27
v_exp_f32 v28, v28
v_exp_f32 v29, v29
v_exp_f32 v30, v30
v_exp_f32 v31, v31
v_add_f32 v47, v24, v25
v_add_f32 v44, v26, v27
v_add_f32 v45, v28, v29
v_add_f32 v48, v30, v31
v_add_f32 v47, v47, v44
v_add_f32 v45, v45, v48
v_add_f32 v47, v47, v45
s_nop 1
v_add_f32_dpp v47, v47, v47 row_ror:8 row_mask:0xf bank_mask:0xf
s_nop 1
v_add_f32_dpp v47, v47, v47 row_ror:4 row_mask:0xf bank_mask:0xf
s_nop 1
v_add_f32_dpp v47, v47, v47 quad_perm:[2,3,0,1] row_mask:0xf bank_mask:0xf
s_nop 1
v_add_f32_dpp v47, v47, v47 quad_perm:[1,0,3,2] row_mask:0xf bank_mask:0xf
s_nop 0
v_readlane_b32 s8, v47, 0
v_readlane_b32 s9, v47, 16
v_readlane_b32 s10, v47, 32
v_readlane_b32 s11, v47, 48
v_mov_b32 v47, s8
v_add_f32 v47, s9, v47
v_add_f32 v47, s10, v47
v_add_f32 v47, s11, v47
v_cvt_pk_bf16_f32 v24, v24, v24
v_cvt_pk_bf16_f32 v25, v25, v25
v_cvt_pk_bf16_f32 v26, v26, v26
v_cvt_pk_bf16_f32 v27, v27, v27
v_cvt_pk_bf16_f32 v28, v28, v28
v_cvt_pk_bf16_f32 v29, v29, v29
v_cvt_pk_bf16_f32 v30, v30, v30
v_cvt_pk_bf16_f32 v31, v31, v31
s_lshl_b32 s8, s3, 3
v_mov_b32 v44, s8
v_mov_b32 v45, 1
v_mov_b32 v48, 0
s_mov_b64 exec, 1
ds_write_b64 v44, v[46:47] offset:40
ds_add_u32 v48, v45 offset:0
s_mov_b64 exec, -1
v_mov_b32 v4, 0
v_mov_b32 v5, 0
v_mov_b32 v6, 0
v_mov_b32 v7, 0
v_and_b32_dpp v8, v24, v36 row_newbcast:0 row_mask:0xf bank_mask:0xf
v_and_b32_dpp v9, v24, v37 row_newbcast:0 row_mask:0xf bank_mask:0xf
v_and_b32_dpp v10, v24, v38 row_newbcast:0 row_mask:0xf bank_mask:0xf
v_and_b32_dpp v11, v24, v39 row_newbcast:0 row_mask:0xf bank_mask:0xf
v_and_b32_dpp v12, v24, v36 row_newbcast:1 row_mask:0xf bank_mask:0xf
v_and_b32_dpp v13, v24, v37 row_newbcast:1 row_mask:0xf bank_mask:0xf
v_and_b32_dpp v14, v24, v38 row_newbcast:1 row_mask:0xf bank_mask:0xf
v_and_b32_dpp v15, v24, v39 row_newbcast:1 row_mask:0xf bank_mask:0xf
v_mfma_f32_16x16x32_bf16 v[4:7], v[8:11], v[128:131], v[4:7]
s_cmp_lg_u32 s76, 0
s_cbranch_scc1 L_pc66
s_waitcnt vmcnt(4)
L_pc66:
s_waitcnt vmcnt(6)
s_add_u32 s65, s65, s43
buffer_load_dwordx4 v[128:131], v2, s[56:59], s65 offen offset:0 nt
v_and_b32_dpp v8, v24, v36 row_newbcast:2 row_mask:0xf bank_mask:0xf
v_and_b32_dpp v9, v24, v37 row_newbcast:2 row_mask:0xf bank_mask:0xf
v_and_b32_dpp v10, v24, v38 row_newbcast:2 row_mask:0xf bank_mask:0xf
v_and_b32_dpp v11, v24, v39 row_newbcast:2 row_mask:0xf bank_mask:0xf
v_mfma_f32_16x16x32_bf16 v[4:7], v[12:15], v[132:135], v[4:7]
s_cmp_lg_u32 s76, 0
s_cbranch_scc1 L_pc67
s_waitcnt vmcnt(4)
L_pc67:
s_waitcnt vmcnt(6)
buffer_load_dwordx4 v[132:135], v2, s[56:59], s65 offen offset:1024 nt
v_and_b32_dpp v12, v24, v36 row_newbcast:3 row_mask:0xf bank_mask:0xf
v_and_b32_dpp v13, v24, v37 row_newbcast:3 row_mask:0xf bank_mask:0xf
v_and_b32_dpp v14, v24, v38 row_newbcast:3 row_mask:0xf bank_mask:0xf
v_and_b32_dpp v15, v24, v39 row_newbcast:3 row_mask:0xf bank_mask:0xf
v_mfma_f32_16x16x32_bf16 v[4:7], v[8:11], v[136:139], v[4:7]
s_cmp_lg_u32 s76, 0
s_cbranch_scc1 L_pc68
s_waitcnt vmcnt(4)
L_pc68:
s_waitcnt vmcnt(6)
buffer_load_dwordx4 v[136:139], v2, s[56:59], s65 offen offset:2048 nt
v_and_b32_dpp v8, v24, v36 row_newbcast:4 row_mask:0xf bank_mask:0xf
v_and_b32_dpp v9, v24, v37 row_newbcast:4 row_mask:0xf bank_mask:0xf
v_and_b32_dpp v10, v24, v38 row_newbcast:4 row_mask:0xf bank_mask:0xf
v_and_b32_dpp v11, v24, v39 row_newbcast:4 row_mask:0xf bank_mask:0xf
v_mfma_f32_16x16x32_bf16 v[4:7], v[12:15], v[140:143], v[4:7]
s_cmp_lg_u32 s76, 0
s_cbranch_scc1 L_pc69
s_waitcnt vmcnt(4)
L_pc69:
s_waitcnt vmcnt(6)
buffer_load_dwordx4 v[140:143], v2, s[56:59], s65 offen offset:3072 nt
v_and_b32_dpp v12, v24, v36 row_newbcast:5 row_mask:0xf bank_mask:0xf
v_and_b32_dpp v13, v24, v37 row_newbcast:5 row_mask:0xf bank_mask:0xf
v_and_b32_dpp v14, v24, v38 row_newbcast:5 row_mask:0xf bank_mask:0xf
v_and_b32_dpp v15, v24, v39 row_newbcast:5 row_mask:0xf bank_mask:0xf
v_mfma_f32_16x16x32_bf16 v[4:7], v[8:11], v[144:147], v[4:7]
s_cmp_lg_u32 s76, 0
s_cbranch_scc1 L_pc70
s_waitcnt vmcnt(4)
L_pc70:
s_waitcnt vmcnt(6)
s_add_u32 s65, s65, s43
buffer_load_dwordx4 v[144:147], v2, s[56:59], s65 offen offset:0 nt
v_and_b32_dpp v8, v24, v36 row_newbcast:6 row_mask:0xf bank_mask:0xf
v_and_b32_dpp v9, v24, v37 row_newbcast:6 row_mask:0xf bank_mask:0xf
v_and_b32_dpp v10, v24, v38 row_newbcast:6 row_mask:0xf bank_mask:0xf
v_and_b32_dpp v11, v24, v39 row_newbcast:6 row_mask:0xf bank_mask:0xf
v_mfma_f32_16x16x32_bf16 v[4:7], v[12:15], v[148:151], v[4:7]
s_cmp_lg_u32 s76, 0
s_cbranch_scc1 L_pc71
s_waitcnt vmcnt(4)
L_pc71:
s_waitcnt vmcnt(6)
buffer_load_dwordx4 v[148:151], v2, s[56:59], s65 offen offset:1024 nt
v_and_b32_dpp v12, v24, v36 row_newbcast:7 row_mask:0xf bank_mask:0xf
v_and_b32_dpp v13, v24, v37 row_newbcast:7 row_mask:0xf bank_mask:0xf
v_and_b32_dpp v14, v24, v38 row_newbcast:7 row_mask:0xf bank_mask:0xf
v_and_b32_dpp v15, v24, v39 row_newbcast:7 row_mask:0xf bank_mask:0xf
v_mfma_f32_16x16x32_bf16 v[4:7], v[8:11], v[152:155], v[4:7]
s_cmp_lg_u32 s76, 0
s_cbranch_scc1 L_pc72
s_waitcnt vmcnt(4)
L_pc72:
s_waitcnt vmcnt(6)
buffer_load_dwordx4 v[152:155], v2, s[56:59], s65 offen offset:2048 nt
v_and_b32_dpp v8, v24, v36 row_newbcast:8 row_mask:0xf bank_mask:0xf
v_and_b32_dpp v9, v24, v37 row_newbcast:8 row_mask:0xf bank_mask:0xf
v_and_b32_dpp v10, v24, v38 row_newbcast:8 row_mask:0xf bank_mask:0xf
v_and_b32_dpp v11, v24, v39 row_newbcast:8 row_mask:0xf bank_mask:0xf
v_mfma_f32_16x16x32_bf16 v[4:7], v[12:15], v[156:159], v[4:7]
s_cmp_lg_u32 s76, 0
s_cbranch_scc1 L_pc73
s_waitcnt vmcnt(4)
L_pc73:
s_waitcnt vmcnt(6)
buffer_load_dwordx4 v[156:159], v2, s[56:59], s65 offen offset:3072 nt
s_waitcnt lgkmcnt(0)
v_readfirstlane_b32 s76, v18
ds_read_b32 v18, v17 offset:20
v_and_b32_dpp v12, v24, v36 row_newbcast:9 row_mask:0xf bank_mask:0xf
v_and_b32_dpp v13, v24, v37 row_newbcast:9 row_mask:0xf bank_mask:0xf
v_and_b32_dpp v14, v24, v38 row_newbcast:9 row_mask:0xf bank_mask:0xf
v_and_b32_dpp v15, v24, v39 row_newbcast:9 row_mask:0xf bank_mask:0xf
v_mfma_f32_16x16x32_bf16 v[4:7], v[8:11], v[160:163], v[4:7]
s_cmp_lg_u32 s76, 0
s_cbranch_scc1 L_pc74
s_waitcnt vmcnt(4)
L_pc74:
s_waitcnt vmcnt(6)
s_add_u32 s65, s65, s43
buffer_load_dwordx4 v[160:163], v2, s[56:59], s65 offen offset:0 nt
v_and_b32_dpp v8, v24, v36 row_newbcast:10 row_mask:0xf bank_mask:0xf
v_and_b32_dpp v9, v24, v37 row_newbcast:10 row_mask:0xf bank_mask:0xf
v_and_b32_dpp v10, v24, v38 row_newbcast:10 row_mask:0xf bank_mask:0xf
v_and_b32_dpp v11, v24, v39 row_newbcast:10 row_mask:0xf bank_mask:0xf
v_mfma_f32_16x16x32_bf16 v[4:7], v[12:15], v[164:167], v[4:7]
s_cmp_lg_u32 s76, 0
s_cbranch_scc1 L_pc75
s_waitcnt vmcnt(4)
L_pc75:
s_waitcnt vmcnt(6)
buffer_load_dwordx4 v[164:167], v2, s[56:59], s65 offen offset:1024 nt
v_and_b32_dpp v12, v24, v36 row_newbcast:11 row_mask:0xf bank_mask:0xf
v_and_b32_dpp v13, v24, v37 row_newbcast:11 row_mask:0xf bank_mask:0xf
v_and_b32_dpp v14, v24, v38 row_newbcast:11 row_mask:0xf bank_mask:0xf
v_and_b32_dpp v15, v24, v39 row_newbcast:11 row_mask:0xf bank_mask:0xf
v_mfma_f32_16x16x32_bf16 v[4:7], v[8:11], v[168:171], v[4:7]
s_cmp_lg_u32 s76, 0
s_cbranch_scc1 L_pc76
s_waitcnt vmcnt(4)
L_pc76:
s_waitcnt vmcnt(6)
buffer_load_dwordx4 v[168:171], v2, s[56:59], s65 offen offset:2048 nt
v_and_b32_dpp v8, v24, v36 row_newbcast:12 row_mask:0xf bank_mask:0xf
v_and_b32_dpp v9, v24, v37 row_newbcast:12 row_mask:0xf bank_mask:0xf
v_and_b32_dpp v10, v24, v38 row_newbcast:12 row_mask:0xf bank_mask:0xf
v_and_b32_dpp v11, v24, v39 row_newbcast:12 row_mask:0xf bank_mask:0xf
v_mfma_f32_16x16x32_bf16 v[4:7], v[12:15], v[172:175], v[4:7]
s_cmp_lg_u32 s76, 0
s_cbranch_scc1 L_pc77
s_waitcnt vmcnt(4)
L_pc77:
s_waitcnt vmcnt(6)
buffer_load_dwordx4 v[172:175], v2, s[56:59], s65 offen offset:3072 nt
v_and_b32_dpp v12, v24, v36 row_newbcast:13 row_mask:0xf bank_mask:0xf
v_and_b32_dpp v13, v24, v37 row_newbcast:13 row_mask:0xf bank_mask:0xf
v_and_b32_dpp v14, v24, v38 row_newbcast:13 row_mask:0xf bank_mask:0xf
v_and_b32_dpp v15, v24, v39 row_newbcast:13 row_mask:0xf bank_mask:0xf
v_mfma_f32_16x16x32_bf16 v[4:7], v[8:11], v[176:179], v[4:7]
s_cmp_lg_u32 s76, 0
s_cbranch_scc1 L_pc78
s_waitcnt vmcnt(4)
L_pc78:
s_waitcnt vmcnt(6)
s_add_u32 s65, s65, s43
buffer_load_dwordx4 v[176:179], v2, s[56:59], s65 offen offset:0 nt
v_and_b32_dpp v8, v24, v36 row_newbcast:14 row_mask:0xf bank_mask:0xf
v_and_b32_dpp v9, v24, v37 row_newbcast:14 row_mask:0xf bank_mask:0xf
v_and_b32_dpp v10, v24, v38 row_newbcast:14 row_mask:0xf bank_mask:0xf
v_and_b32_dpp v11, v24, v39 row_newbcast:14 row_mask:0xf bank_mask:0xf
v_mfma_f32_16x16x32_bf16 v[4:7], v[12:15], v[180:183], v[4:7]
s_cmp_lg_u32 s76, 0
s_cbranch_scc1 L_pc79
s_waitcnt vmcnt(4)
L_pc79:
s_waitcnt vmcnt(6)
buffer_load_dwordx4 v[180:183], v2, s[56:59], s65 offen offset:1024 nt
v_and_b32_dpp v12, v24, v36 row_newbcast:15 row_mask:0xf bank_mask:0xf
v_and_b32_dpp v13, v24, v37 row_newbcast:15 row_mask:0xf bank_mask:0xf
v_and_b32_dpp v14, v24, v38 row_newbcast:15 row_mask:0xf bank_mask:0xf
v_and_b32_dpp v15, v24, v39 row_newbcast:15 row_mask:0xf bank_mask:0xf
v_mfma_f32_16x16x32_bf16 v[4:7], v[8:11], v[184:187], v[4:7]
s_cmp_lg_u32 s76, 0
s_cbranch_scc1 L_pc80
s_waitcnt vmcnt(4)
L_pc80:
s_waitcnt vmcnt(6)
buffer_load_dwordx4 v[184:187], v2, s[56:59], s65 offen offset:2048 nt
v_and_b32_dpp v8, v25, v36 row_newbcast:0 row_mask:0xf bank_mask:0xf
v_and_b32_dpp v9, v25, v37 row_newbcast:0 row_mask:0xf bank_mask:0xf
v_and_b32_dpp v10, v25, v38 row_newbcast:0 row_mask:0xf bank_mask:0xf
v_and_b32_dpp v11, v25, v39 row_newbcast:0 row_mask:0xf bank_mask:0xf
v_mfma_f32_16x16x32_bf16 v[4:7], v[12:15], v[188:191], v[4:7]
s_cmp_lg_u32 s76, 0
s_cbranch_scc1 L_pc81
s_waitcnt vmcnt(4)
L_pc81:
s_waitcnt vmcnt(6)
buffer_load_dwordx4 v[188:191], v2, s[56:59], s65 offen offset:3072 nt
s_waitcnt lgkmcnt(0)
v_readfirstlane_b32 s76, v18
ds_read_b32 v18, v17 offset:20
v_and_b32_dpp v12, v25, v36 row_newbcast:1 row_mask:0xf bank_mask:0xf
v_and_b32_dpp v13, v25, v37 row_newbcast:1 row_mask:0xf bank_mask:0xf
v_and_b32_dpp v14, v25, v38 row_newbcast:1 row_mask:0xf bank_mask:0xf
v_and_b32_dpp v15, v25, v39 row_newbcast:1 row_mask:0xf bank_mask:0xf
v_mfma_f32_16x16x32_bf16 v[4:7], v[8:11], v[192:195], v[4:7]
s_cmp_lg_u32 s76, 0
s_cbranch_scc1 L_pc82
s_waitcnt vmcnt(4)
L_pc82:
s_waitcnt vmcnt(6)
s_add_u32 s65, s65, s43
buffer_load_dwordx4 v[192:195], v2, s[56:59], s65 offen offset:0 nt
v_and_b32_dpp v8, v25, v36 row_newbcast:2 row_mask:0xf bank_mask:0xf
v_and_b32_dpp v9, v25, v37 row_newbcast:2 row_mask:0xf bank_mask:0xf
v_and_b32_dpp v10, v25, v38 row_newbcast:2 row_mask:0xf bank_mask:0xf
v_and_b32_dpp v11, v25, v39 row_newbcast:2 row_mask:0xf bank_mask:0xf
v_mfma_f32_16x16x32_bf16 v[4:7], v[12:15], v[196:199], v[4:7]
s_cmp_lg_u32 s76, 0
s_cbranch_scc1 L_pc83
s_waitcnt vmcnt(4)
L_pc83:
s_waitcnt vmcnt(6)
buffer_load_dwordx4 v[196:199], v2, s[56:59], s65 offen offset:1024 nt
v_and_b32_dpp v12, v25, v36 row_newbcast:3 row_mask:0xf bank_mask:0xf
v_and_b32_dpp v13, v25, v37 row_newbcast:3 row_mask:0xf bank_mask:0xf
v_and_b32_dpp v14, v25, v38 row_newbcast:3 row_mask:0xf bank_mask:0xf
v_and_b32_dpp v15, v25, v39 row_newbcast:3 row_mask:0xf bank_mask:0xf
v_mfma_f32_16x16x32_bf16 v[4:7], v[8:11], v[200:203], v[4:7]
s_cmp_lg_u32 s76, 0
s_cbranch_scc1 L_pc84
s_waitcnt vmcnt(4)
L_pc84:
s_waitcnt vmcnt(6)
buffer_load_dwordx4 v[200:203], v2, s[56:59], s65 offen offset:2048 nt
v_and_b32_dpp v8, v25, v36 row_newbcast:4 row_mask:0xf bank_mask:0xf
v_and_b32_dpp v9, v25, v37 row_newbcast:4 row_mask:0xf bank_mask:0xf
v_and_b32_dpp v10, v25, v38 row_newbcast:4 row_mask:0xf bank_mask:0xf
v_and_b32_dpp v11, v25, v39 row_newbcast:4 row_mask:0xf bank_mask:0xf
v_mfma_f32_16x16x32_bf16 v[4:7], v[12:15], v[204:207], v[4:7]
s_cmp_lg_u32 s76, 0
s_cbranch_scc1 L_pc85
s_waitcnt vmcnt(4)
L_pc85:
s_waitcnt vmcnt(6)
buffer_load_dwordx4 v[204:207], v2, s[56:59], s65 offen offset:3072 nt
v_and_b32_dpp v12, v25, v36 row_newbcast:5 row_mask:0xf bank_mask:0xf
v_and_b32_dpp v13, v25, v37 row_newbcast:5 row_mask:0xf bank_mask:0xf
v_and_b32_dpp v14, v25, v38 row_newbcast:5 row_mask:0xf bank_mask:0xf
v_and_b32_dpp v15, v25, v39 row_newbcast:5 row_mask:0xf bank_mask:0xf
v_mfma_f32_16x16x32_bf16 v[4:7], v[8:11], v[208:211], v[4:7]
s_cmp_lg_u32 s76, 0
s_cbranch_scc1 L_pc86
s_waitcnt vmcnt(4)
L_pc86:
s_waitcnt vmcnt(6)
s_add_u32 s65, s65, s43
buffer_load_dwordx4 v[208:211], v2, s[56:59], s65 offen offset:0 nt
v_and_b32_dpp v8, v25, v36 row_newbcast:6 row_mask:0xf bank_mask:0xf
v_and_b32_dpp v9, v25, v37 row_newbcast:6 row_mask:0xf bank_mask:0xf
v_and_b32_dpp v10, v25, v38 row_newbcast:6 row_mask:0xf bank_mask:0xf
v_and_b32_dpp v11, v25, v39 row_newbcast:6 row_mask:0xf bank_mask:0xf
v_mfma_f32_16x16x32_bf16 v[4:7], v[12:15], v[212:215], v[4:7]
s_cmp_lg_u32 s76, 0
s_cbranch_scc1 L_pc87
s_waitcnt vmcnt(4)
L_pc87:
s_waitcnt vmcnt(6)
buffer_load_dwordx4 v[212:215], v2, s[56:59], s65 offen offset:1024 nt
v_and_b32_dpp v12, v25, v36 row_newbcast:7 row_mask:0xf bank_mask:0xf
v_and_b32_dpp v13, v25, v37 row_newbcast:7 row_mask:0xf bank_mask:0xf
v_and_b32_dpp v14, v25, v38 row_newbcast:7 row_mask:0xf bank_mask:0xf
v_and_b32_dpp v15, v25, v39 row_newbcast:7 row_mask:0xf bank_mask:0xf
v_mfma_f32_16x16x32_bf16 v[4:7], v[8:11], v[216:219], v[4:7]
s_cmp_lg_u32 s76, 0
s_cbranch_scc1 L_pc88
s_waitcnt vmcnt(4)
L_pc88:
s_waitcnt vmcnt(6)
buffer_load_dwordx4 v[216:219], v2, s[56:59], s65 offen offset:2048 nt
v_and_b32_dpp v8, v25, v36 row_newbcast:8 row_mask:0xf bank_mask:0xf
v_and_b32_dpp v9, v25, v37 row_newbcast:8 row_mask:0xf bank_mask:0xf
v_and_b32_dpp v10, v25, v38 row_newbcast:8 row_mask:0xf bank_mask:0xf
v_and_b32_dpp v11, v25, v39 row_newbcast:8 row_mask:0xf bank_mask:0xf
v_mfma_f32_16x16x32_bf16 v[4:7], v[12:15], v[220:223], v[4:7]
s_cmp_lg_u32 s76, 0
s_cbranch_scc1 L_pc89
s_waitcnt vmcnt(4)
L_pc89:
s_waitcnt vmcnt(6)
buffer_load_dwordx4 v[220:223], v2, s[56:59], s65 offen offset:3072 nt
s_waitcnt lgkmcnt(0)
v_readfirstlane_b32 s76, v18
ds_read_b32 v18, v17 offset:20
v_and_b32_dpp v12, v25, v36 row_newbcast:9 row_mask:0xf bank_mask:0xf
v_and_b32_dpp v13, v25, v37 row_newbcast:9 row_mask:0xf bank_mask:0xf
v_and_b32_dpp v14, v25, v38 row_newbcast:9 row_mask:0xf bank_mask:0xf
v_and_b32_dpp v15, v25, v39 row_newbcast:9 row_mask:0xf bank_mask:0xf
v_mfma_f32_16x16x32_bf16 v[4:7], v[8:11], v[224:227], v[4:7]
s_cmp_lg_u32 s76, 0
s_cbranch_scc1 L_pc90
s_waitcnt vmcnt(4)
L_pc90:
s_waitcnt vmcnt(6)
s_add_u32 s65, s65, s43
buffer_load_dwordx4 v[224:227], v2, s[56:59], s65 offen offset:0 nt
v_and_b32_dpp v8, v25, v36 row_newbcast:10 row_mask:0xf bank_mask:0xf
v_and_b32_dpp v9, v25, v37 row_newbcast:10 row_mask:0xf bank_mask:0xf
v_and_b32_dpp v10, v25, v38 row_newbcast:10 row_mask:0xf bank_mask:0xf
v_and_b32_dpp v11, v25, v39 row_newbcast:10 row_mask:0xf bank_mask:0xf
v_mfma_f32_16x16x32_bf16 v[4:7], v[12:15], v[228:231], v[4:7]
s_cmp_lg_u32 s76, 0
s_cbranch_scc1 L_pc91
s_waitcnt vmcnt(4)
L_pc91:
s_waitcnt vmcnt(6)
buffer_load_dwordx4 v[228:231], v2, s[56:59], s65 offen offset:1024 nt
v_and_b32_dpp v12, v25, v36 row_newbcast:11 row_mask:0xf bank_mask:0xf
v_and_b32_dpp v13, v25, v37 row_newbcast:11 row_mask:0xf bank_mask:0xf
v_and_b32_dpp v14, v25, v38 row_newbcast:11 row_mask:0xf bank_mask:0xf
v_and_b32_dpp v15, v25, v39 row_newbcast:11 row_mask:0xf bank_mask:0xf
v_mfma_f32_16x16x32_bf16 v[4:7], v[8:11], v[232:235], v[4:7]
s_cmp_lg_u32 s76, 0
s_cbranch_scc1 L_pc92
s_waitcnt vmcnt(4)
L_pc92:
s_waitcnt vmcnt(6)
buffer_load_dwordx4 v[232:235], v2, s[56:59], s65 offen offset:2048 nt
v_and_b32_dpp v8, v25, v36 row_newbcast:12 row_mask:0xf bank_mask:0xf
v_and_b32_dpp v9, v25, v37 row_newbcast:12 row_mask:0xf bank_mask:0xf
v_and_b32_dpp v10, v25, v38 row_newbcast:12 row_mask:0xf bank_mask:0xf
v_and_b32_dpp v11, v25, v39 row_newbcast:12 row_mask:0xf bank_mask:0xf
v_mfma_f32_16x16x32_bf16 v[4:7], v[12:15], v[236:239], v[4:7]
s_cmp_lg_u32 s76, 0
s_cbranch_scc1 L_pc93
s_waitcnt vmcnt(4)
L_pc93:
s_waitcnt vmcnt(6)
buffer_load_dwordx4 v[236:239], v2, s[56:59], s65 offen offset:3072 nt
v_and_b32_dpp v12, v25, v36 row_newbcast:13 row_mask:0xf bank_mask:0xf
v_and_b32_dpp v13, v25, v37 row_newbcast:13 row_mask:0xf bank_mask:0xf
v_and_b32_dpp v14, v25, v38 row_newbcast:13 row_mask:0xf bank_mask:0xf
v_and_b32_dpp v15, v25, v39 row_newbcast:13 row_mask:0xf bank_mask:0xf
v_mfma_f32_16x16x32_bf16 v[4:7], v[8:11], v[240:243], v[4:7]
s_cmp_lg_u32 s76, 0
s_cbranch_scc1 L_pc94
s_waitcnt vmcnt(4)
L_pc94:
s_waitcnt vmcnt(6)
s_add_u32 s65, s65, s43
buffer_load_dwordx4 v[240:243], v2, s[56:59], s65 offen offset:0 nt
v_and_b32_dpp v8, v25, v36 row_newbcast:14 row_mask:0xf bank_mask:0xf
v_and_b32_dpp v9, v25, v37 row_newbcast:14 row_mask:0xf bank_mask:0xf
v_and_b32_dpp v10, v25, v38 row_newbcast:14 row_mask:0xf bank_mask:0xf
v_and_b32_dpp v11, v25, v39 row_newbcast:14 row_mask:0xf bank_mask:0xf
v_mfma_f32_16x16x32_bf16 v[4:7], v[12:15], v[244:247], v[4:7]
s_cmp_lg_u32 s76, 0
s_cbranch_scc1 L_pc95
s_waitcnt vmcnt(4)
L_pc95:
s_waitcnt vmcnt(6)
buffer_load_dwordx4 v[244:247], v2, s[56:59], s65 offen offset:1024 nt
v_and_b32_dpp v12, v25, v36 row_newbcast:15 row_mask:0xf bank_mask:0xf
v_and_b32_dpp v13, v25, v37 row_newbcast:15 row_mask:0xf bank_mask:0xf
v_and_b32_dpp v14, v25, v38 row_newbcast:15 row_mask:0xf bank_mask:0xf
v_and_b32_dpp v15, v25, v39 row_newbcast:15 row_mask:0xf bank_mask:0xf
v_mfma_f32_16x16x32_bf16 v[4:7], v[8:11], v[248:251], v[4:7]
s_cmp_lg_u32 s76, 0
s_cbranch_scc1 L_pc96
s_waitcnt vmcnt(4)
L_pc96:
s_waitcnt vmcnt(6)
buffer_load_dwordx4 v[248:251], v2, s[56:59], s65 offen offset:2048 nt
v_and_b32_dpp v8, v26, v36 row_newbcast:0 row_mask:0xf bank_mask:0xf
v_and_b32_dpp v9, v26, v37 row_newbcast:0 row_mask:0xf bank_mask:0xf
v_and_b32_dpp v10, v26, v38 row_newbcast:0 row_mask:0xf bank_mask:0xf
v_and_b32_dpp v11, v26, v39 row_newbcast:0 row_mask:0xf bank_mask:0xf
v_mfma_f32_16x16x32_bf16 v[4:7], v[12:15], v[252:255], v[4:7]
s_cmp_lg_u32 s76, 0
s_cbranch_scc1 L_pc97
s_waitcnt vmcnt(4)
L_pc97:
s_waitcnt vmcnt(6)
buffer_load_dwordx4 v[252:255], v2, s[56:59], s65 offen offset:3072 nt
s_mov_b64 exec, 1
ds_add_u32 v17, v19 offset:16
s_mov_b64 exec, -1
s_waitcnt lgkmcnt(0)
v_readfirstlane_b32 s76, v18
ds_read_b32 v18, v17 offset:20
v_and_b32_dpp v12, v26, v36 row_newbcast:1 row_mask:0xf bank_mask:0xf
v_and_b32_dpp v13, v26, v37 row_newbcast:1 row_mask:0xf bank_mask:0xf
v_and_b32_dpp v14, v26, v38 row_newbcast:1 row_mask:0xf bank_mask:0xf
v_and_b32_dpp v15, v26, v39 row_newbcast:1 row_mask:0xf bank_mask:0xf
v_mfma_f32_16x16x32_bf16 v[4:7], v[8:11], v[128:131], v[4:7]
s_cmp_lg_u32 s76, 0
s_cbranch_scc1 L_pc98
s_waitcnt vmcnt(4)
L_pc98:
s_waitcnt vmcnt(6)
s_add_u32 s65, s65, s43
buffer_load_dwordx4 v[128:131], v2, s[56:59], s65 offen offset:0 nt
v_and_b32_dpp v8, v26, v36 row_newbcast:2 row_mask:0xf bank_mask:0xf
v_and_b32_dpp v9, v26, v37 row_newbcast:2 row_mask:0xf bank_mask:0xf
v_and_b32_dpp v10, v26, v38 row_newbcast:2 row_mask:0xf bank_mask:0xf
v_and_b32_dpp v11, v26, v39 row_newbcast:2 row_mask:0xf bank_mask:0xf
v_mfma_f32_16x16x32_bf16 v[4:7], v[12:15], v[132:135], v[4:7]
s_cmp_lg_u32 s76, 0
s_cbranch_scc1 L_pc99
s_waitcnt vmcnt(4)
L_pc99:
s_waitcnt vmcnt(6)
buffer_load_dwordx4 v[132:135], v2, s[56:59], s65 offen offset:1024 nt
v_and_b32_dpp v12, v26, v36 row_newbcast:3 row_mask:0xf bank_mask:0xf
v_and_b32_dpp v13, v26, v37 row_newbcast:3 row_mask:0xf bank_mask:0xf
v_and_b32_dpp v14, v26, v38 row_newbcast:3 row_mask:0xf bank_mask:0xf
v_and_b32_dpp v15, v26, v39 row_newbcast:3 row_mask:0xf bank_mask:0xf
v_mfma_f32_16x16x32_bf16 v[4:7], v[8:11], v[136:139], v[4:7]
s_cmp_lg_u32 s76, 0
s_cbranch_scc1 L_pc100
s_waitcnt vmcnt(4)
L_pc100:
s_waitcnt vmcnt(6)
buffer_load_dwordx4 v[136:139], v2, s[56:59], s65 offen offset:2048 nt
v_and_b32_dpp v8, v26, v36 row_newbcast:4 row_mask:0xf bank_mask:0xf
v_and_b32_dpp v9, v26, v37 row_newbcast:4 row_mask:0xf bank_mask:0xf
v_and_b32_dpp v10, v26, v38 row_newbcast:4 row_mask:0xf bank_mask:0xf
v_and_b32_dpp v11, v26, v39 row_newbcast:4 row_mask:0xf bank_mask:0xf
v_mfma_f32_16x16x32_bf16 v[4:7], v[12:15], v[140:143], v[4:7]
s_cmp_lg_u32 s76, 0
s_cbranch_scc1 L_pc101
s_waitcnt vmcnt(4)
L_pc101:
s_waitcnt vmcnt(6)
buffer_load_dwordx4 v[140:143], v2, s[56:59], s65 offen offset:3072 nt
v_and_b32_dpp v12, v26, v36 row_newbcast:5 row_mask:0xf bank_mask:0xf
v_and_b32_dpp v13, v26, v37 row_newbcast:5 row_mask:0xf bank_mask:0xf
v_and_b32_dpp v14, v26, v38 row_newbcast:5 row_mask:0xf bank_mask:0xf
v_and_b32_dpp v15, v26, v39 row_newbcast:5 row_mask:0xf bank_mask:0xf
v_mfma_f32_16x16x32_bf16 v[4:7], v[8:11], v[144:147], v[4:7]
s_cmp_lg_u32 s76, 0
s_cbranch_scc1 L_pc102
s_waitcnt vmcnt(4)
L_pc102:
s_waitcnt vmcnt(6)
s_add_u32 s65, s65, s43
buffer_load_dwordx4 v[144:147], v2, s[56:59], s65 offen offset:0 nt
v_and_b32_dpp v8, v26, v36 row_newbcast:6 row_mask:0xf bank_mask:0xf
v_and_b32_dpp v9, v26, v37 row_newbcast:6 row_mask:0xf bank_mask:0xf
v_and_b32_dpp v10, v26, v38 row_newbcast:6 row_mask:0xf bank_mask:0xf
v_and_b32_dpp v11, v26, v39 row_newbcast:6 row_mask:0xf bank_mask:0xf
v_mfma_f32_16x16x32_bf16 v[4:7], v[12:15], v[148:151], v[4:7]
s_cmp_lg_u32 s76, 0
s_cbranch_scc1 L_pc103
s_waitcnt vmcnt(4)
L_pc103:
s_waitcnt vmcnt(6)
buffer_load_dwordx4 v[148:151], v2, s[56:59], s65 offen offset:1024 nt
v_and_b32_dpp v12, v26, v36 row_newbcast:7 row_mask:0xf bank_mask:0xf
v_and_b32_dpp v13, v26, v37 row_newbcast:7 row_mask:0xf bank_mask:0xf
v_and_b32_dpp v14, v26, v38 row_newbcast:7 row_mask:0xf bank_mask:0xf
v_and_b32_dpp v15, v26, v39 row_newbcast:7 row_mask:0xf bank_mask:0xf
v_mfma_f32_16x16x32_bf16 v[4:7], v[8:11], v[152:155], v[4:7]
s_cmp_lg_u32 s76, 0
s_cbranch_scc1 L_pc104
s_waitcnt vmcnt(4)
L_pc104:
s_waitcnt vmcnt(6)
buffer_load_dwordx4 v[152:155], v2, s[56:59], s65 offen offset:2048 nt
v_and_b32_dpp v8, v26, v36 row_newbcast:8 row_mask:0xf bank_mask:0xf
v_and_b32_dpp v9, v26, v37 row_newbcast:8 row_mask:0xf bank_mask:0xf
v_and_b32_dpp v10, v26, v38 row_newbcast:8 row_mask:0xf bank_mask:0xf
v_and_b32_dpp v11, v26, v39 row_newbcast:8 row_mask:0xf bank_mask:0xf
v_mfma_f32_16x16x32_bf16 v[4:7], v[12:15], v[156:159], v[4:7]
s_cmp_lg_u32 s76, 0
s_cbranch_scc1 L_pc105
s_waitcnt vmcnt(4)
L_pc105:
s_waitcnt vmcnt(6)
buffer_load_dwordx4 v[156:159], v2, s[56:59], s65 offen offset:3072 nt
s_waitcnt lgkmcnt(0)
v_readfirstlane_b32 s76, v18
ds_read_b32 v18, v17 offset:20
v_and_b32_dpp v12, v26, v36 row_newbcast:9 row_mask:0xf bank_mask:0xf
v_and_b32_dpp v13, v26, v37 row_newbcast:9 row_mask:0xf bank_mask:0xf
v_and_b32_dpp v14, v26, v38 row_newbcast:9 row_mask:0xf bank_mask:0xf
v_and_b32_dpp v15, v26, v39 row_newbcast:9 row_mask:0xf bank_mask:0xf
v_mfma_f32_16x16x32_bf16 v[4:7], v[8:11], v[160:163], v[4:7]
s_cmp_lg_u32 s76, 0
s_cbranch_scc1 L_pc106
s_waitcnt vmcnt(4)
L_pc106:
s_waitcnt vmcnt(6)
s_add_u32 s65, s65, s43
buffer_load_dwordx4 v[160:163], v2, s[56:59], s65 offen offset:0 nt
v_and_b32_dpp v8, v26, v36 row_newbcast:10 row_mask:0xf bank_mask:0xf
v_and_b32_dpp v9, v26, v37 row_newbcast:10 row_mask:0xf bank_mask:0xf
v_and_b32_dpp v10, v26, v38 row_newbcast:10 row_mask:0xf bank_mask:0xf
v_and_b32_dpp v11, v26, v39 row_newbcast:10 row_mask:0xf bank_mask:0xf
v_mfma_f32_16x16x32_bf16 v[4:7], v[12:15], v[164:167], v[4:7]
s_cmp_lg_u32 s76, 0
s_cbranch_scc1 L_pc107
s_waitcnt vmcnt(4)
L_pc107:
s_waitcnt vmcnt(6)
buffer_load_dwordx4 v[164:167], v2, s[56:59], s65 offen offset:1024 nt
v_and_b32_dpp v12, v26, v36 row_newbcast:11 row_mask:0xf bank_mask:0xf
v_and_b32_dpp v13, v26, v37 row_newbcast:11 row_mask:0xf bank_mask:0xf
v_and_b32_dpp v14, v26, v38 row_newbcast:11 row_mask:0xf bank_mask:0xf
v_and_b32_dpp v15, v26, v39 row_newbcast:11 row_mask:0xf bank_mask:0xf
v_mfma_f32_16x16x32_bf16 v[4:7], v[8:11], v[168:171], v[4:7]
s_cmp_lg_u32 s76, 0
s_cbranch_scc1 L_pc108
s_waitcnt vmcnt(4)
L_pc108:
s_waitcnt vmcnt(6)
buffer_load_dwordx4 v[168:171], v2, s[56:59], s65 offen offset:2048 nt
v_and_b32_dpp v8, v26, v36 row_newbcast:12 row_mask:0xf bank_mask:0xf
v_and_b32_dpp v9, v26, v37 row_newbcast:12 row_mask:0xf bank_mask:0xf
v_and_b32_dpp v10, v26, v38 row_newbcast:12 row_mask:0xf bank_mask:0xf
v_and_b32_dpp v11, v26, v39 row_newbcast:12 row_mask:0xf bank_mask:0xf
v_mfma_f32_16x16x32_bf16 v[4:7], v[12:15], v[172:175], v[4:7]
s_cmp_lg_u32 s76, 0
s_cbranch_scc1 L_pc109
s_waitcnt vmcnt(4)
L_pc109:
s_waitcnt vmcnt(6)
buffer_load_dwordx4 v[172:175], v2, s[56:59], s65 offen offset:3072 nt
v_and_b32_dpp v12, v26, v36 row_newbcast:13 row_mask:0xf bank_mask:0xf
v_and_b32_dpp v13, v26, v37 row_newbcast:13 row_mask:0xf bank_mask:0xf
v_and_b32_dpp v14, v26, v38 row_newbcast:13 row_mask:0xf bank_mask:0xf
v_and_b32_dpp v15, v26, v39 row_newbcast:13 row_mask:0xf bank_mask:0xf
v_mfma_f32_16x16x32_bf16 v[4:7], v[8:11], v[176:179], v[4:7]
s_cmp_lg_u32 s76, 0
s_cbranch_scc1 L_pc110
s_waitcnt vmcnt(4)
L_pc110:
s_waitcnt vmcnt(6)
s_add_u32 s65, s65, s43
buffer_load_dwordx4 v[176:179], v2, s[56:59], s65 offen offset:0 nt
v_and_b32_dpp v8, v26, v36 row_newbcast:14 row_mask:0xf bank_mask:0xf
v_and_b32_dpp v9, v26, v37 row_newbcast:14 row_mask:0xf bank_mask:0xf
v_and_b32_dpp v10, v26, v38 row_newbcast:14 row_mask:0xf bank_mask:0xf
v_and_b32_dpp v11, v26, v39 row_newbcast:14 row_mask:0xf bank_mask:0xf
v_mfma_f32_16x16x32_bf16 v[4:7], v[12:15], v[180:183], v[4:7]
s_cmp_lg_u32 s76, 0
s_cbranch_scc1 L_pc111
s_waitcnt vmcnt(4)
L_pc111:
s_waitcnt vmcnt(6)
buffer_load_dwordx4 v[180:183], v2, s[56:59], s65 offen offset:1024 nt
v_and_b32_dpp v12, v26, v36 row_newbcast:15 row_mask:0xf bank_mask:0xf
v_and_b32_dpp v13, v26, v37 row_newbcast:15 row_mask:0xf bank_mask:0xf
v_and_b32_dpp v14, v26, v38 row_newbcast:15 row_mask:0xf bank_mask:0xf
v_and_b32_dpp v15, v26, v39 row_newbcast:15 row_mask:0xf bank_mask:0xf
v_mfma_f32_16x16x32_bf16 v[4:7], v[8:11], v[184:187], v[4:7]
s_cmp_lg_u32 s76, 0
s_cbranch_scc1 L_pc112
s_waitcnt vmcnt(4)
L_pc112:
s_waitcnt vmcnt(6)
buffer_load_dwordx4 v[184:187], v2, s[56:59], s65 offen offset:2048 nt
v_and_b32_dpp v8, v27, v36 row_newbcast:0 row_mask:0xf bank_mask:0xf
v_and_b32_dpp v9, v27, v37 row_newbcast:0 row_mask:0xf bank_mask:0xf
v_and_b32_dpp v10, v27, v38 row_newbcast:0 row_mask:0xf bank_mask:0xf
v_and_b32_dpp v11, v27, v39 row_newbcast:0 row_mask:0xf bank_mask:0xf
v_mfma_f32_16x16x32_bf16 v[4:7], v[12:15], v[188:191], v[4:7]
s_cmp_lg_u32 s76, 0
s_cbranch_scc1 L_pc113
s_waitcnt vmcnt(4)
L_pc113:
s_waitcnt vmcnt(6)
buffer_load_dwordx4 v[188:191], v2, s[56:59], s65 offen offset:3072 nt
s_waitcnt lgkmcnt(0)
v_readfirstlane_b32 s76, v18
ds_read_b32 v18, v17 offset:20
v_and_b32_dpp v12, v27, v36 row_newbcast:1 row_mask:0xf bank_mask:0xf
v_and_b32_dpp v13, v27, v37 row_newbcast:1 row_mask:0xf bank_mask:0xf
v_and_b32_dpp v14, v27, v38 row_newbcast:1 row_mask:0xf bank_mask:0xf
v_and_b32_dpp v15, v27, v39 row_newbcast:1 row_mask:0xf bank_mask:0xf
v_mfma_f32_16x16x32_bf16 v[4:7], v[8:11], v[192:195], v[4:7]
s_cmp_lg_u32 s76, 0
s_cbranch_scc1 L_pc114
s_waitcnt vmcnt(4)
L_pc114:
s_waitcnt vmcnt(6)
s_add_u32 s65, s65, s43
buffer_load_dwordx4 v[192:195], v2, s[56:59], s65 offen offset:0 nt
v_and_b32_dpp v8, v27, v36 row_newbcast:2 row_mask:0xf bank_mask:0xf
v_and_b32_dpp v9, v27, v37 row_newbcast:2 row_mask:0xf bank_mask:0xf
v_and_b32_dpp v10, v27, v38 row_newbcast:2 row_mask:0xf bank_mask:0xf
v_and_b32_dpp v11, v27, v39 row_newbcast:2 row_mask:0xf bank_mask:0xf
v_mfma_f32_16x16x32_bf16 v[4:7], v[12:15], v[196:199], v[4:7]
s_cmp_lg_u32 s76, 0
s_cbranch_scc1 L_pc115
s_waitcnt vmcnt(4)
L_pc115:
s_waitcnt vmcnt(6)
buffer_load_dwordx4 v[196:199], v2, s[56:59], s65 offen offset:1024 nt
v_and_b32_dpp v12, v27, v36 row_newbcast:3 row_mask:0xf bank_mask:0xf
v_and_b32_dpp v13, v27, v37 row_newbcast:3 row_mask:0xf bank_mask:0xf
v_and_b32_dpp v14, v27, v38 row_newbcast:3 row_mask:0xf bank_mask:0xf
v_and_b32_dpp v15, v27, v39 row_newbcast:3 row_mask:0xf bank_mask:0xf
v_mfma_f32_16x16x32_bf16 v[4:7], v[8:11], v[200:203], v[4:7]
s_cmp_lg_u32 s76, 0
s_cbranch_scc1 L_pc116
s_waitcnt vmcnt(4)
L_pc116:
s_waitcnt vmcnt(6)
buffer_load_dwordx4 v[200:203], v2, s[56:59], s65 offen offset:2048 nt
v_and_b32_dpp v8, v27, v36 row_newbcast:4 row_mask:0xf bank_mask:0xf
v_and_b32_dpp v9, v27, v37 row_newbcast:4 row_mask:0xf bank_mask:0xf
v_and_b32_dpp v10, v27, v38 row_newbcast:4 row_mask:0xf bank_mask:0xf
v_and_b32_dpp v11, v27, v39 row_newbcast:4 row_mask:0xf bank_mask:0xf
v_mfma_f32_16x16x32_bf16 v[4:7], v[12:15], v[204:207], v[4:7]
s_cmp_lg_u32 s76, 0
s_cbranch_scc1 L_pc117
s_waitcnt vmcnt(4)
L_pc117:
s_waitcnt vmcnt(6)
buffer_load_dwordx4 v[204:207], v2, s[56:59], s65 offen offset:3072 nt
v_and_b32_dpp v12, v27, v36 row_newbcast:5 row_mask:0xf bank_mask:0xf
v_and_b32_dpp v13, v27, v37 row_newbcast:5 row_mask:0xf bank_mask:0xf
v_and_b32_dpp v14, v27, v38 row_newbcast:5 row_mask:0xf bank_mask:0xf
v_and_b32_dpp v15, v27, v39 row_newbcast:5 row_mask:0xf bank_mask:0xf
v_mfma_f32_16x16x32_bf16 v[4:7], v[8:11], v[208:211], v[4:7]
s_cmp_lg_u32 s76, 0
s_cbranch_scc1 L_pc118
s_waitcnt vmcnt(4)
L_pc118:
s_waitcnt vmcnt(6)
s_add_u32 s65, s65, s43
buffer_load_dwordx4 v[208:211], v2, s[56:59], s65 offen offset:0 nt
v_and_b32_dpp v8, v27, v36 row_newbcast:6 row_mask:0xf bank_mask:0xf
v_and_b32_dpp v9, v27, v37 row_newbcast:6 row_mask:0xf bank_mask:0xf
v_and_b32_dpp v10, v27, v38 row_newbcast:6 row_mask:0xf bank_mask:0xf
v_and_b32_dpp v11, v27, v39 row_newbcast:6 row_mask:0xf bank_mask:0xf
v_mfma_f32_16x16x32_bf16 v[4:7], v[12:15], v[212:215], v[4:7]
s_cmp_lg_u32 s76, 0
s_cbranch_scc1 L_pc119
s_waitcnt vmcnt(4)
L_pc119:
s_waitcnt vmcnt(6)
buffer_load_dwordx4 v[212:215], v2, s[56:59], s65 offen offset:1024 nt
v_and_b32_dpp v12, v27, v36 row_newbcast:7 row_mask:0xf bank_mask:0xf
v_and_b32_dpp v13, v27, v37 row_newbcast:7 row_mask:0xf bank_mask:0xf
v_and_b32_dpp v14, v27, v38 row_newbcast:7 row_mask:0xf bank_mask:0xf
v_and_b32_dpp v15, v27, v39 row_newbcast:7 row_mask:0xf bank_mask:0xf
v_mfma_f32_16x16x32_bf16 v[4:7], v[8:11], v[216:219], v[4:7]
s_cmp_lg_u32 s76, 0
s_cbranch_scc1 L_pc120
s_waitcnt vmcnt(4)
L_pc120:
s_waitcnt vmcnt(6)
buffer_load_dwordx4 v[216:219], v2, s[56:59], s65 offen offset:2048 nt
v_and_b32_dpp v8, v27, v36 row_newbcast:8 row_mask:0xf bank_mask:0xf
v_and_b32_dpp v9, v27, v37 row_newbcast:8 row_mask:0xf bank_mask:0xf
v_and_b32_dpp v10, v27, v38 row_newbcast:8 row_mask:0xf bank_mask:0xf
v_and_b32_dpp v11, v27, v39 row_newbcast:8 row_mask:0xf bank_mask:0xf
v_mfma_f32_16x16x32_bf16 v[4:7], v[12:15], v[220:223], v[4:7]
s_cmp_lg_u32 s76, 0
s_cbranch_scc1 L_pc121
s_waitcnt vmcnt(4)
L_pc121:
s_waitcnt vmcnt(6)
buffer_load_dwordx4 v[220:223], v2, s[56:59], s65 offen offset:3072 nt
s_waitcnt lgkmcnt(0)
v_readfirstlane_b32 s76, v18
ds_read_b32 v18, v17 offset:20
v_and_b32_dpp v12, v27, v36 row_newbcast:9 row_mask:0xf bank_mask:0xf
v_and_b32_dpp v13, v27, v37 row_newbcast:9 row_mask:0xf bank_mask:0xf
v_and_b32_dpp v14, v27, v38 row_newbcast:9 row_mask:0xf bank_mask:0xf
v_and_b32_dpp v15, v27, v39 row_newbcast:9 row_mask:0xf bank_mask:0xf
v_mfma_f32_16x16x32_bf16 v[4:7], v[8:11], v[224:227], v[4:7]
s_cmp_lg_u32 s76, 0
s_cbranch_scc1 L_pc122
s_waitcnt vmcnt(4)
L_pc122:
s_waitcnt vmcnt(6)
s_add_u32 s65, s65, s43
buffer_load_dwordx4 v[224:227], v2, s[56:59], s65 offen offset:0 nt
v_and_b32_dpp v8, v27, v36 row_newbcast:10 row_mask:0xf bank_mask:0xf
v_and_b32_dpp v9, v27, v37 row_newbcast:10 row_mask:0xf bank_mask:0xf
v_and_b32_dpp v10, v27, v38 row_newbcast:10 row_mask:0xf bank_mask:0xf
v_and_b32_dpp v11, v27, v39 row_newbcast:10 row_mask:0xf bank_mask:0xf
v_mfma_f32_16x16x32_bf16 v[4:7], v[12:15], v[228:231], v[4:7]
s_cmp_lg_u32 s76, 0
s_cbranch_scc1 L_pc123
s_waitcnt vmcnt(4)
L_pc123:
s_waitcnt vmcnt(6)
buffer_load_dwordx4 v[228:231], v2, s[56:59], s65 offen offset:1024 nt
v_and_b32_dpp v12, v27, v36 row_newbcast:11 row_mask:0xf bank_mask:0xf
v_and_b32_dpp v13, v27, v37 row_newbcast:11 row_mask:0xf bank_mask:0xf
v_and_b32_dpp v14, v27, v38 row_newbcast:11 row_mask:0xf bank_mask:0xf
v_and_b32_dpp v15, v27, v39 row_newbcast:11 row_mask:0xf bank_mask:0xf
v_mfma_f32_16x16x32_bf16 v[4:7], v[8:11], v[232:235], v[4:7]
s_cmp_lg_u32 s76, 0
s_cbranch_scc1 L_pc124
s_waitcnt vmcnt(4)
L_pc124:
s_waitcnt vmcnt(6)
buffer_load_dwordx4 v[232:235], v2, s[56:59], s65 offen offset:2048 nt
v_and_b32_dpp v8, v27, v36 row_newbcast:12 row_mask:0xf bank_mask:0xf
v_and_b32_dpp v9, v27, v37 row_newbcast:12 row_mask:0xf bank_mask:0xf
v_and_b32_dpp v10, v27, v38 row_newbcast:12 row_mask:0xf bank_mask:0xf
v_and_b32_dpp v11, v27, v39 row_newbcast:12 row_mask:0xf bank_mask:0xf
v_mfma_f32_16x16x32_bf16 v[4:7], v[12:15], v[236:239], v[4:7]
s_cmp_lg_u32 s76, 0
s_cbranch_scc1 L_pc125
s_waitcnt vmcnt(4)
L_pc125:
s_waitcnt vmcnt(6)
buffer_load_dwordx4 v[236:239], v2, s[56:59], s65 offen offset:3072 nt
v_and_b32_dpp v12, v27, v36 row_newbcast:13 row_mask:0xf bank_mask:0xf
v_and_b32_dpp v13, v27, v37 row_newbcast:13 row_mask:0xf bank_mask:0xf
v_and_b32_dpp v14, v27, v38 row_newbcast:13 row_mask:0xf bank_mask:0xf
v_and_b32_dpp v15, v27, v39 row_newbcast:13 row_mask:0xf bank_mask:0xf
v_mfma_f32_16x16x32_bf16 v[4:7], v[8:11], v[240:243], v[4:7]
s_cmp_lg_u32 s76, 0
s_cbranch_scc1 L_pc126
s_waitcnt vmcnt(4)
L_pc126:
s_waitcnt vmcnt(6)
s_add_u32 s65, s65, s43
buffer_load_dwordx4 v[240:243], v2, s[56:59], s65 offen offset:0 nt
v_and_b32_dpp v8, v27, v36 row_newbcast:14 row_mask:0xf bank_mask:0xf
v_and_b32_dpp v9, v27, v37 row_newbcast:14 row_mask:0xf bank_mask:0xf
v_and_b32_dpp v10, v27, v38 row_newbcast:14 row_mask:0xf bank_mask:0xf
v_and_b32_dpp v11, v27, v39 row_newbcast:14 row_mask:0xf bank_mask:0xf
v_mfma_f32_16x16x32_bf16 v[4:7], v[12:15], v[244:247], v[4:7]
s_cmp_lg_u32 s76, 0
s_cbranch_scc1 L_pc127
s_waitcnt vmcnt(4)
L_pc127:
s_waitcnt vmcnt(6)
buffer_load_dwordx4 v[244:247], v2, s[56:59], s65 offen offset:1024 nt
v_and_b32_dpp v12, v27, v36 row_newbcast:15 row_mask:0xf bank_mask:0xf
v_and_b32_dpp v13, v27, v37 row_newbcast:15 row_mask:0xf bank_mask:0xf
v_and_b32_dpp v14, v27, v38 row_newbcast:15 row_mask:0xf bank_mask:0xf
v_and_b32_dpp v15, v27, v39 row_newbcast:15 row_mask:0xf bank_mask:0xf
v_mfma_f32_16x16x32_bf16 v[4:7], v[8:11], v[248:251], v[4:7]
s_cmp_lg_u32 s76, 0
s_cbranch_scc1 L_pc128
s_waitcnt vmcnt(4)
L_pc128:
s_waitcnt vmcnt(6)
buffer_load_dwordx4 v[248:251], v2, s[56:59], s65 offen offset:2048 nt
v_and_b32_dpp v8, v28, v36 row_newbcast:0 row_mask:0xf bank_mask:0xf
v_and_b32_dpp v9, v28, v37 row_newbcast:0 row_mask:0xf bank_mask:0xf
v_and_b32_dpp v10, v28, v38 row_newbcast:0 row_mask:0xf bank_mask:0xf
v_and_b32_dpp v11, v28, v39 row_newbcast:0 row_mask:0xf bank_mask:0xf
v_mfma_f32_16x16x32_bf16 v[4:7], v[12:15], v[252:255], v[4:7]
s_cmp_lg_u32 s76, 0
s_cbranch_scc1 L_pc129
s_waitcnt vmcnt(4)
L_pc129:
s_waitcnt vmcnt(6)
buffer_load_dwordx4 v[252:255], v2, s[56:59], s65 offen offset:3072 nt
s_mov_b64 exec, 1
ds_add_u32 v17, v19 offset:16
s_mov_b64 exec, -1
s_waitcnt lgkmcnt(0)
v_readfirstlane_b32 s76, v18
ds_read_b32 v18, v17 offset:20
v_and_b32_dpp v12, v28, v36 row_newbcast:1 row_mask:0xf bank_mask:0xf
v_and_b32_dpp v13, v28, v37 row_newbcast:1 row_mask:0xf bank_mask:0xf
v_and_b32_dpp v14, v28, v38 row_newbcast:1 row_mask:0xf bank_mask:0xf
v_and_b32_dpp v15, v28, v39 row_newbcast:1 row_mask:0xf bank_mask:0xf
v_mfma_f32_16x16x32_bf16 v[4:7], v[8:11], v[128:131], v[4:7]
s_cmp_lg_u32 s76, 0
s_cbranch_scc1 L_pc130
s_waitcnt vmcnt(4)
L_pc130:
s_waitcnt vmcnt(6)
s_add_u32 s65, s65, s43
buffer_load_dwordx4 v[128:131], v2, s[56:59], s65 offen offset:0 nt
v_and_b32_dpp v8, v28, v36 row_newbcast:2 row_mask:0xf bank_mask:0xf
v_and_b32_dpp v9, v28, v37 row_newbcast:2 row_mask:0xf bank_mask:0xf
v_and_b32_dpp v10, v28, v38 row_newbcast:2 row_mask:0xf bank_mask:0xf
v_and_b32_dpp v11, v28, v39 row_newbcast:2 row_mask:0xf bank_mask:0xf
v_mfma_f32_16x16x32_bf16 v[4:7], v[12:15], v[132:135], v[4:7]
s_cmp_lg_u32 s76, 0
s_cbranch_scc1 L_pc131
s_waitcnt vmcnt(4)
L_pc131:
s_waitcnt vmcnt(6)
buffer_load_dwordx4 v[132:135], v2, s[56:59], s65 offen offset:1024 nt
v_and_b32_dpp v12, v28, v36 row_newbcast:3 row_mask:0xf bank_mask:0xf
v_and_b32_dpp v13, v28, v37 row_newbcast:3 row_mask:0xf bank_mask:0xf
v_and_b32_dpp v14, v28, v38 row_newbcast:3 row_mask:0xf bank_mask:0xf
v_and_b32_dpp v15, v28, v39 row_newbcast:3 row_mask:0xf bank_mask:0xf
v_mfma_f32_16x16x32_bf16 v[4:7], v[8:11], v[136:139], v[4:7]
s_cmp_lg_u32 s76, 0
s_cbranch_scc1 L_pc132
s_waitcnt vmcnt(4)
L_pc132:
s_waitcnt vmcnt(6)
buffer_load_dwordx4 v[136:139], v2, s[56:59], s65 offen offset:2048 nt
v_and_b32_dpp v8, v28, v36 row_newbcast:4 row_mask:0xf bank_mask:0xf
v_and_b32_dpp v9, v28, v37 row_newbcast:4 row_mask:0xf bank_mask:0xf
v_and_b32_dpp v10, v28, v38 row_newbcast:4 row_mask:0xf bank_mask:0xf
v_and_b32_dpp v11, v28, v39 row_newbcast:4 row_mask:0xf bank_mask:0xf
v_mfma_f32_16x16x32_bf16 v[4:7], v[12:15], v[140:143], v[4:7]
s_cmp_lg_u32 s76, 0
s_cbranch_scc1 L_pc133
s_waitcnt vmcnt(4)
L_pc133:
s_waitcnt vmcnt(6)
buffer_load_dwordx4 v[140:143], v2, s[56:59], s65 offen offset:3072 nt
v_and_b32_dpp v12, v28, v36 row_newbcast:5 row_mask:0xf bank_mask:0xf
v_and_b32_dpp v13, v28, v37 row_newbcast:5 row_mask:0xf bank_mask:0xf
v_and_b32_dpp v14, v28, v38 row_newbcast:5 row_mask:0xf bank_mask:0xf
v_and_b32_dpp v15, v28, v39 row_newbcast:5 row_mask:0xf bank_mask:0xf
v_mfma_f32_16x16x32_bf16 v[4:7], v[8:11], v[144:147], v[4:7]
s_cmp_lg_u32 s76, 0
s_cbranch_scc1 L_pc134
s_waitcnt vmcnt(4)
L_pc134:
s_waitcnt vmcnt(6)
s_add_u32 s65, s65, s43
buffer_load_dwordx4 v[144:147], v2, s[56:59], s65 offen offset:0 nt
v_and_b32_dpp v8, v28, v36 row_newbcast:6 row_mask:0xf bank_mask:0xf
v_and_b32_dpp v9, v28, v37 row_newbcast:6 row_mask:0xf bank_mask:0xf
v_and_b32_dpp v10, v28, v38 row_newbcast:6 row_mask:0xf bank_mask:0xf
v_and_b32_dpp v11, v28, v39 row_newbcast:6 row_mask:0xf bank_mask:0xf
v_mfma_f32_16x16x32_bf16 v[4:7], v[12:15], v[148:151], v[4:7]
s_cmp_lg_u32 s76, 0
s_cbranch_scc1 L_pc135
s_waitcnt vmcnt(4)
L_pc135:
s_waitcnt vmcnt(6)
buffer_load_dwordx4 v[148:151], v2, s[56:59], s65 offen offset:1024 nt
v_and_b32_dpp v12, v28, v36 row_newbcast:7 row_mask:0xf bank_mask:0xf
v_and_b32_dpp v13, v28, v37 row_newbcast:7 row_mask:0xf bank_mask:0xf
v_and_b32_dpp v14, v28, v38 row_newbcast:7 row_mask:0xf bank_mask:0xf
v_and_b32_dpp v15, v28, v39 row_newbcast:7 row_mask:0xf bank_mask:0xf
v_mfma_f32_16x16x32_bf16 v[4:7], v[8:11], v[152:155], v[4:7]
s_cmp_lg_u32 s76, 0
s_cbranch_scc1 L_pc136
s_waitcnt vmcnt(4)
L_pc136:
s_waitcnt vmcnt(6)
buffer_load_dwordx4 v[152:155], v2, s[56:59], s65 offen offset:2048 nt
v_and_b32_dpp v8, v28, v36 row_newbcast:8 row_mask:0xf bank_mask:0xf
v_and_b32_dpp v9, v28, v37 row_newbcast:8 row_mask:0xf bank_mask:0xf
v_and_b32_dpp v10, v28, v38 row_newbcast:8 row_mask:0xf bank_mask:0xf
v_and_b32_dpp v11, v28, v39 row_newbcast:8 row_mask:0xf bank_mask:0xf
v_mfma_f32_16x16x32_bf16 v[4:7], v[12:15], v[156:159], v[4:7]
s_cmp_lg_u32 s76, 0
s_cbranch_scc1 L_pc137
s_waitcnt vmcnt(4)
L_pc137:
s_waitcnt vmcnt(6)
buffer_load_dwordx4 v[156:159], v2, s[56:59], s65 offen offset:3072 nt
s_waitcnt lgkmcnt(0)
v_readfirstlane_b32 s76, v18
ds_read_b32 v18, v17 offset:20
v_and_b32_dpp v12, v28, v36 row_newbcast:9 row_mask:0xf bank_mask:0xf
v_and_b32_dpp v13, v28, v37 row_newbcast:9 row_mask:0xf bank_mask:0xf
v_and_b32_dpp v14, v28, v38 row_newbcast:9 row_mask:0xf bank_mask:0xf
v_and_b32_dpp v15, v28, v39 row_newbcast:9 row_mask:0xf bank_mask:0xf
v_mfma_f32_16x16x32_bf16 v[4:7], v[8:11], v[160:163], v[4:7]
s_cmp_lg_u32 s76, 0
s_cbranch_scc1 L_pc138
s_waitcnt vmcnt(4)
L_pc138:
s_waitcnt vmcnt(6)
s_add_u32 s65, s65, s43
buffer_load_dwordx4 v[160:163], v2, s[56:59], s65 offen offset:0 nt
v_and_b32_dpp v8, v28, v36 row_newbcast:10 row_mask:0xf bank_mask:0xf
v_and_b32_dpp v9, v28, v37 row_newbcast:10 row_mask:0xf bank_mask:0xf
v_and_b32_dpp v10, v28, v38 row_newbcast:10 row_mask:0xf bank_mask:0xf
v_and_b32_dpp v11, v28, v39 row_newbcast:10 row_mask:0xf bank_mask:0xf
v_mfma_f32_16x16x32_bf16 v[4:7], v[12:15], v[164:167], v[4:7]
s_cmp_lg_u32 s76, 0
s_cbranch_scc1 L_pc139
s_waitcnt vmcnt(4)
L_pc139:
s_waitcnt vmcnt(6)
buffer_load_dwordx4 v[164:167], v2, s[56:59], s65 offen offset:1024 nt
v_and_b32_dpp v12, v28, v36 row_newbcast:11 row_mask:0xf bank_mask:0xf
v_and_b32_dpp v13, v28, v37 row_newbcast:11 row_mask:0xf bank_mask:0xf
v_and_b32_dpp v14, v28, v38 row_newbcast:11 row_mask:0xf bank_mask:0xf
v_and_b32_dpp v15, v28, v39 row_newbcast:11 row_mask:0xf bank_mask:0xf
v_mfma_f32_16x16x32_bf16 v[4:7], v[8:11], v[168:171], v[4:7]
s_cmp_lg_u32 s76, 0
s_cbranch_scc1 L_pc140
s_waitcnt vmcnt(4)
L_pc140:
s_waitcnt vmcnt(6)
buffer_load_dwordx4 v[168:171], v2, s[56:59], s65 offen offset:2048 nt
v_and_b32_dpp v8, v28, v36 row_newbcast:12 row_mask:0xf bank_mask:0xf
v_and_b32_dpp v9, v28, v37 row_newbcast:12 row_mask:0xf bank_mask:0xf
v_and_b32_dpp v10, v28, v38 row_newbcast:12 row_mask:0xf bank_mask:0xf
v_and_b32_dpp v11, v28, v39 row_newbcast:12 row_mask:0xf bank_mask:0xf
v_mfma_f32_16x16x32_bf16 v[4:7], v[12:15], v[172:175], v[4:7]
s_cmp_lg_u32 s76, 0
s_cbranch_scc1 L_pc141
s_waitcnt vmcnt(4)
L_pc141:
s_waitcnt vmcnt(6)
buffer_load_dwordx4 v[172:175], v2, s[56:59], s65 offen offset:3072 nt
v_and_b32_dpp v12, v28, v36 row_newbcast:13 row_mask:0xf bank_mask:0xf
v_and_b32_dpp v13, v28, v37 row_newbcast:13 row_mask:0xf bank_mask:0xf
v_and_b32_dpp v14, v28, v38 row_newbcast:13 row_mask:0xf bank_mask:0xf
v_and_b32_dpp v15, v28, v39 row_newbcast:13 row_mask:0xf bank_mask:0xf
v_mfma_f32_16x16x32_bf16 v[4:7], v[8:11], v[176:179], v[4:7]
s_cmp_lg_u32 s76, 0
s_cbranch_scc1 L_pc142
s_waitcnt vmcnt(4)
L_pc142:
s_waitcnt vmcnt(6)
s_add_u32 s65, s65, s43
buffer_load_dwordx4 v[176:179], v2, s[56:59], s65 offen offset:0 nt
v_and_b32_dpp v8, v28, v36 row_newbcast:14 row_mask:0xf bank_mask:0xf
v_and_b32_dpp v9, v28, v37 row_newbcast:14 row_mask:0xf bank_mask:0xf
v_and_b32_dpp v10, v28, v38 row_newbcast:14 row_mask:0xf bank_mask:0xf
v_and_b32_dpp v11, v28, v39 row_newbcast:14 row_mask:0xf bank_mask:0xf
v_mfma_f32_16x16x32_bf16 v[4:7], v[12:15], v[180:183], v[4:7]
s_cmp_lg_u32 s76, 0
s_cbranch_scc1 L_pc143
s_waitcnt vmcnt(4)
L_pc143:
s_waitcnt vmcnt(6)
buffer_load_dwordx4 v[180:183], v2, s[56:59], s65 offen offset:1024 nt
v_and_b32_dpp v12, v28, v36 row_newbcast:15 row_mask:0xf bank_mask:0xf
v_and_b32_dpp v13, v28, v37 row_newbcast:15 row_mask:0xf bank_mask:0xf
v_and_b32_dpp v14, v28, v38 row_newbcast:15 row_mask:0xf bank_mask:0xf
v_and_b32_dpp v15, v28, v39 row_newbcast:15 row_mask:0xf bank_mask:0xf
v_mfma_f32_16x16x32_bf16 v[4:7], v[8:11], v[184:187], v[4:7]
s_cmp_lg_u32 s76, 0
s_cbranch_scc1 L_pc144
s_waitcnt vmcnt(4)
L_pc144:
s_waitcnt vmcnt(6)
buffer_load_dwordx4 v[184:187], v2, s[56:59], s65 offen offset:2048 nt
v_and_b32_dpp v8, v29, v36 row_newbcast:0 row_mask:0xf bank_mask:0xf
v_and_b32_dpp v9, v29, v37 row_newbcast:0 row_mask:0xf bank_mask:0xf
v_and_b32_dpp v10, v29, v38 row_newbcast:0 row_mask:0xf bank_mask:0xf
v_and_b32_dpp v11, v29, v39 row_newbcast:0 row_mask:0xf bank_mask:0xf
v_mfma_f32_16x16x32_bf16 v[4:7], v[12:15], v[188:191], v[4:7]
s_cmp_lg_u32 s76, 0
s_cbranch_scc1 L_pc145
s_waitcnt vmcnt(4)
L_pc145:
s_waitcnt vmcnt(6)
buffer_load_dwordx4 v[188:191], v2, s[56:59], s65 offen offset:3072 nt
s_waitcnt lgkmcnt(0)
v_readfirstlane_b32 s76, v18
ds_read_b32 v18, v17 offset:20
v_and_b32_dpp v12, v29, v36 row_newbcast:1 row_mask:0xf bank_mask:0xf
v_and_b32_dpp v13, v29, v37 row_newbcast:1 row_mask:0xf bank_mask:0xf
v_and_b32_dpp v14, v29, v38 row_newbcast:1 row_mask:0xf bank_mask:0xf
v_and_b32_dpp v15, v29, v39 row_newbcast:1 row_mask:0xf bank_mask:0xf
v_mfma_f32_16x16x32_bf16 v[4:7], v[8:11], v[192:195], v[4:7]
s_cmp_lg_u32 s76, 0
s_cbranch_scc1 L_pc146
s_waitcnt vmcnt(4)
L_pc146:
s_waitcnt vmcnt(6)
s_add_u32 s65, s65, s43
buffer_load_dwordx4 v[192:195], v2, s[56:59], s65 offen offset:0 nt
v_and_b32_dpp v8, v29, v36 row_newbcast:2 row_mask:0xf bank_mask:0xf
v_and_b32_dpp v9, v29, v37 row_newbcast:2 row_mask:0xf bank_mask:0xf
v_and_b32_dpp v10, v29, v38 row_newbcast:2 row_mask:0xf bank_mask:0xf
v_and_b32_dpp v11, v29, v39 row_newbcast:2 row_mask:0xf bank_mask:0xf
v_mfma_f32_16x16x32_bf16 v[4:7], v[12:15], v[196:199], v[4:7]
s_cmp_lg_u32 s76, 0
s_cbranch_scc1 L_pc147
s_waitcnt vmcnt(4)
L_pc147:
s_waitcnt vmcnt(6)
buffer_load_dwordx4 v[196:199], v2, s[56:59], s65 offen offset:1024 nt
v_and_b32_dpp v12, v29, v36 row_newbcast:3 row_mask:0xf bank_mask:0xf
v_and_b32_dpp v13, v29, v37 row_newbcast:3 row_mask:0xf bank_mask:0xf
v_and_b32_dpp v14, v29, v38 row_newbcast:3 row_mask:0xf bank_mask:0xf
v_and_b32_dpp v15, v29, v39 row_newbcast:3 row_mask:0xf bank_mask:0xf
v_mfma_f32_16x16x32_bf16 v[4:7], v[8:11], v[200:203], v[4:7]
s_cmp_lg_u32 s76, 0
s_cbranch_scc1 L_pc148
s_waitcnt vmcnt(4)
L_pc148:
s_waitcnt vmcnt(6)
buffer_load_dwordx4 v[200:203], v2, s[56:59], s65 offen offset:2048 nt
v_and_b32_dpp v8, v29, v36 row_newbcast:4 row_mask:0xf bank_mask:0xf
v_and_b32_dpp v9, v29, v37 row_newbcast:4 row_mask:0xf bank_mask:0xf
v_and_b32_dpp v10, v29, v38 row_newbcast:4 row_mask:0xf bank_mask:0xf
v_and_b32_dpp v11, v29, v39 row_newbcast:4 row_mask:0xf bank_mask:0xf
v_mfma_f32_16x16x32_bf16 v[4:7], v[12:15], v[204:207], v[4:7]
s_cmp_lg_u32 s76, 0
s_cbranch_scc1 L_pc149
s_waitcnt vmcnt(4)
L_pc149:
s_waitcnt vmcnt(6)
buffer_load_dwordx4 v[204:207], v2, s[56:59], s65 offen offset:3072 nt
v_and_b32_dpp v12, v29, v36 row_newbcast:5 row_mask:0xf bank_mask:0xf
v_and_b32_dpp v13, v29, v37 row_newbcast:5 row_mask:0xf bank_mask:0xf
v_and_b32_dpp v14, v29, v38 row_newbcast:5 row_mask:0xf bank_mask:0xf
v_and_b32_dpp v15, v29, v39 row_newbcast:5 row_mask:0xf bank_mask:0xf
v_mfma_f32_16x16x32_bf16 v[4:7], v[8:11], v[208:211], v[4:7]
s_cmp_lg_u32 s76, 0
s_cbranch_scc1 L_pc150
s_waitcnt vmcnt(4)
L_pc150:
s_waitcnt vmcnt(6)
s_add_u32 s65, s65, s43
buffer_load_dwordx4 v[208:211], v2, s[56:59], s65 offen offset:0 nt
v_and_b32_dpp v8, v29, v36 row_newbcast:6 row_mask:0xf bank_mask:0xf
v_and_b32_dpp v9, v29, v37 row_newbcast:6 row_mask:0xf bank_mask:0xf
v_and_b32_dpp v10, v29, v38 row_newbcast:6 row_mask:0xf bank_mask:0xf
v_and_b32_dpp v11, v29, v39 row_newbcast:6 row_mask:0xf bank_mask:0xf
v_mfma_f32_16x16x32_bf16 v[4:7], v[12:15], v[212:215], v[4:7]
s_cmp_lg_u32 s76, 0
s_cbranch_scc1 L_pc151
s_waitcnt vmcnt(4)
L_pc151:
s_waitcnt vmcnt(6)
buffer_load_dwordx4 v[212:215], v2, s[56:59], s65 offen offset:1024 nt
v_and_b32_dpp v12, v29, v36 row_newbcast:7 row_mask:0xf bank_mask:0xf
v_and_b32_dpp v13, v29, v37 row_newbcast:7 row_mask:0xf bank_mask:0xf
v_and_b32_dpp v14, v29, v38 row_newbcast:7 row_mask:0xf bank_mask:0xf
v_and_b32_dpp v15, v29, v39 row_newbcast:7 row_mask:0xf bank_mask:0xf
v_mfma_f32_16x16x32_bf16 v[4:7], v[8:11], v[216:219], v[4:7]
s_cmp_lg_u32 s76, 0
s_cbranch_scc1 L_pc152
s_waitcnt vmcnt(4)
L_pc152:
s_waitcnt vmcnt(6)
buffer_load_dwordx4 v[216:219], v2, s[56:59], s65 offen offset:2048 nt
v_and_b32_dpp v8, v29, v36 row_newbcast:8 row_mask:0xf bank_mask:0xf
v_and_b32_dpp v9, v29, v37 row_newbcast:8 row_mask:0xf bank_mask:0xf
v_and_b32_dpp v10, v29, v38 row_newbcast:8 row_mask:0xf bank_mask:0xf
v_and_b32_dpp v11, v29, v39 row_newbcast:8 row_mask:0xf bank_mask:0xf
v_mfma_f32_16x16x32_bf16 v[4:7], v[12:15], v[220:223], v[4:7]
s_cmp_lg_u32 s76, 0
s_cbranch_scc1 L_pc153
s_waitcnt vmcnt(4)
L_pc153:
s_waitcnt vmcnt(6)
buffer_load_dwordx4 v[220:223], v2, s[56:59], s65 offen offset:3072 nt
s_waitcnt lgkmcnt(0)
v_readfirstlane_b32 s76, v18
ds_read_b32 v18, v17 offset:20
v_and_b32_dpp v12, v29, v36 row_newbcast:9 row_mask:0xf bank_mask:0xf
v_and_b32_dpp v13, v29, v37 row_newbcast:9 row_mask:0xf bank_mask:0xf
v_and_b32_dpp v14, v29, v38 row_newbcast:9 row_mask:0xf bank_mask:0xf
v_and_b32_dpp v15, v29, v39 row_newbcast:9 row_mask:0xf bank_mask:0xf
v_mfma_f32_16x16x32_bf16 v[4:7], v[8:11], v[224:227], v[4:7]
s_cmp_lg_u32 s76, 0
s_cbranch_scc1 L_pc154
s_waitcnt vmcnt(4)
L_pc154:
s_waitcnt vmcnt(6)
s_add_u32 s65, s65, s43
buffer_load_dwordx4 v[224:227], v2, s[56:59], s65 offen offset:0 nt
v_and_b32_dpp v8, v29, v36 row_newbcast:10 row_mask:0xf bank_mask:0xf
v_and_b32_dpp v9, v29, v37 row_newbcast:10 row_mask:0xf bank_mask:0xf
v_and_b32_dpp v10, v29, v38 row_newbcast:10 row_mask:0xf bank_mask:0xf
v_and_b32_dpp v11, v29, v39 row_newbcast:10 row_mask:0xf bank_mask:0xf
v_mfma_f32_16x16x32_bf16 v[4:7], v[12:15], v[228:231], v[4:7]
s_cmp_lg_u32 s76, 0
s_cbranch_scc1 L_pc155
s_waitcnt vmcnt(4)
L_pc155:
s_waitcnt vmcnt(6)
buffer_load_dwordx4 v[228:231], v2, s[56:59], s65 offen offset:1024 nt
v_and_b32_dpp v12, v29, v36 row_newbcast:11 row_mask:0xf bank_mask:0xf
v_and_b32_dpp v13, v29, v37 row_newbcast:11 row_mask:0xf bank_mask:0xf
v_and_b32_dpp v14, v29, v38 row_newbcast:11 row_mask:0xf bank_mask:0xf
v_and_b32_dpp v15, v29, v39 row_newbcast:11 row_mask:0xf bank_mask:0xf
v_mfma_f32_16x16x32_bf16 v[4:7], v[8:11], v[232:235], v[4:7]
s_cmp_lg_u32 s76, 0
s_cbranch_scc1 L_pc156
s_waitcnt vmcnt(4)
L_pc156:
s_waitcnt vmcnt(6)
buffer_load_dwordx4 v[232:235], v2, s[56:59], s65 offen offset:2048 nt
v_and_b32_dpp v8, v29, v36 row_newbcast:12 row_mask:0xf bank_mask:0xf
v_and_b32_dpp v9, v29, v37 row_newbcast:12 row_mask:0xf bank_mask:0xf
v_and_b32_dpp v10, v29, v38 row_newbcast:12 row_mask:0xf bank_mask:0xf
v_and_b32_dpp v11, v29, v39 row_newbcast:12 row_mask:0xf bank_mask:0xf
v_mfma_f32_16x16x32_bf16 v[4:7], v[12:15], v[236:239], v[4:7]
s_cmp_lg_u32 s76, 0
s_cbranch_scc1 L_pc157
s_waitcnt vmcnt(4)
L_pc157:
s_waitcnt vmcnt(6)
buffer_load_dwordx4 v[236:239], v2, s[56:59], s65 offen offset:3072 nt
v_and_b32_dpp v12, v29, v36 row_newbcast:13 row_mask:0xf bank_mask:0xf
v_and_b32_dpp v13, v29, v37 row_newbcast:13 row_mask:0xf bank_mask:0xf
v_and_b32_dpp v14, v29, v38 row_newbcast:13 row_mask:0xf bank_mask:0xf
v_and_b32_dpp v15, v29, v39 row_newbcast:13 row_mask:0xf bank_mask:0xf
v_mfma_f32_16x16x32_bf16 v[4:7], v[8:11], v[240:243], v[4:7]
s_cmp_lg_u32 s76, 0
s_cbranch_scc1 L_pc158
s_waitcnt vmcnt(4)
L_pc158:
s_waitcnt vmcnt(6)
s_add_u32 s65, s65, s43
buffer_load_dwordx4 v[240:243], v2, s[56:59], s65 offen offset:0 nt
v_and_b32_dpp v8, v29, v36 row_newbcast:14 row_mask:0xf bank_mask:0xf
v_and_b32_dpp v9, v29, v37 row_newbcast:14 row_mask:0xf bank_mask:0xf
v_and_b32_dpp v10, v29, v38 row_newbcast:14 row_mask:0xf bank_mask:0xf
v_and_b32_dpp v11, v29, v39 row_newbcast:14 row_mask:0xf bank_mask:0xf
v_mfma_f32_16x16x32_bf16 v[4:7], v[12:15], v[244:247], v[4:7]
s_cmp_lg_u32 s76, 0
s_cbranch_scc1 L_pc159
s_waitcnt vmcnt(4)
L_pc159:
s_waitcnt vmcnt(6)
buffer_load_dwordx4 v[244:247], v2, s[56:59], s65 offen offset:1024 nt
v_and_b32_dpp v12, v29, v36 row_newbcast:15 row_mask:0xf bank_mask:0xf
v_and_b32_dpp v13, v29, v37 row_newbcast:15 row_mask:0xf bank_mask:0xf
v_and_b32_dpp v14, v29, v38 row_newbcast:15 row_mask:0xf bank_mask:0xf
v_and_b32_dpp v15, v29, v39 row_newbcast:15 row_mask:0xf bank_mask:0xf
v_mfma_f32_16x16x32_bf16 v[4:7], v[8:11], v[248:251], v[4:7]
s_cmp_lg_u32 s76, 0
s_cbranch_scc1 L_pc160
s_waitcnt vmcnt(4)
L_pc160:
s_waitcnt vmcnt(6)
buffer_load_dwordx4 v[248:251], v2, s[56:59], s65 offen offset:2048 nt
v_and_b32_dpp v8, v30, v36 row_newbcast:0 row_mask:0xf bank_mask:0xf
v_and_b32_dpp v9, v30, v37 row_newbcast:0 row_mask:0xf bank_mask:0xf
v_and_b32_dpp v10, v30, v38 row_newbcast:0 row_mask:0xf bank_mask:0xf
v_and_b32_dpp v11, v30, v39 row_newbcast:0 row_mask:0xf bank_mask:0xf
v_mfma_f32_16x16x32_bf16 v[4:7], v[12:15], v[252:255], v[4:7]
s_cmp_lg_u32 s76, 0
s_cbranch_scc1 L_pc161
s_waitcnt vmcnt(4)
L_pc161:
s_waitcnt vmcnt(6)
buffer_load_dwordx4 v[252:255], v2, s[56:59], s65 offen offset:3072 nt
s_mov_b64 exec, 1
ds_add_u32 v17, v19 offset:16
s_mov_b64 exec, -1
s_waitcnt lgkmcnt(0)
v_readfirstlane_b32 s76, v18
ds_read_b32 v18, v17 offset:20
v_mov_b32 v44, 0
s_mov_b32 s73, 200000
L_sp162:
ds_read_b32 v45, v44 offset:8
s_waitcnt lgkmcnt(0)
v_readfirstlane_b32 s8, v45
s_cmp_lg_u32 s8, 0
s_cbranch_scc1 L_sp162_ok
s_sleep 2
s_sub_u32 s73, s73, 1
s_cbranch_scc0 L_sp162
L_sp162_ok:
s_lshl_b32 s8, s3, 2
v_mov_b32 v44, s8
ds_read_b32 v50, v44 offset:72
v_lshlrev_b32 v60, 5, v35
v_lshlrev_b32 v61, 4, v34
v_add_u32 v60, v60, v61
s_lshl_b32 s8, s3, 9
v_add_u32 v60, s8, v60
v_lshlrev_b32 v61, 4, v1
s_lshl_b32 s8, s7, 1
s_add_u32 s8, s8, s6
s_lshl_b32 s8, s8, 9
s_add_u32 s8, s8, 917504
v_add_u32 v62, s8, v61
v_add_u32 v63, 0xfffc0000, v62
s_mov_b32 s14, 0xffffff00
v_and_b32 v20, 0xff, v16
v_bfe_u32 v21, v16, 8, 8
v_bfe_u32 v22, v16, 16, 8
v_bfe_u32 v23, v16, 24, 8
v_and_b32_dpp v12, v30, v36 row_newbcast:1 row_mask:0xf bank_mask:0xf
v_and_b32_dpp v13, v30, v37 row_newbcast:1 row_mask:0xf bank_mask:0xf
v_and_b32_dpp v14, v30, v38 row_newbcast:1 row_mask:0xf bank_mask:0xf
v_and_b32_dpp v15, v30, v39 row_newbcast:1 row_mask:0xf bank_mask:0xf
v_mfma_f32_16x16x32_bf16 v[4:7], v[8:11], v[128:131], v[4:7]
v_and_b32_dpp v8, v30, v36 row_newbcast:2 row_mask:0xf bank_mask:0xf
v_and_b32_dpp v9, v30, v37 row_newbcast:2 row_mask:0xf bank_mask:0xf
v_and_b32_dpp v10, v30, v38 row_newbcast:2 row_mask:0xf bank_mask:0xf
v_and_b32_dpp v11, v30, v39 row_newbcast:2 row_mask:0xf bank_mask:0xf
v_mfma_f32_16x16x32_bf16 v[4:7], v[12:15], v[132:135], v[4:7]
v_and_b32_dpp v12, v30, v36 row_newbcast:3 row_mask:0xf bank_mask:0xf
v_and_b32_dpp v13, v30, v37 row_newbcast:3 row_mask:0xf bank_mask:0xf
v_and_b32_dpp v14, v30, v38 row_newbcast:3 row_mask:0xf bank_mask:0xf
v_and_b32_dpp v15, v30, v39 row_newbcast:3 row_mask:0xf bank_mask:0xf
v_mfma_f32_16x16x32_bf16 v[4:7], v[8:11], v[136:139], v[4:7]
v_and_b32_dpp v8, v30, v36 row_newbcast:4 row_mask:0xf bank_mask:0xf
v_and_b32_dpp v9, v30, v37 row_newbcast:4 row_mask:0xf bank_mask:0xf
v_and_b32_dpp v10, v30, v38 row_newbcast:4 row_mask:0xf bank_mask:0xf
v_and_b32_dpp v11, v30, v39 row_newbcast:4 row_mask:0xf bank_mask:0xf
v_mfma_f32_16x16x32_bf16 v[4:7], v[12:15], v[140:143], v[4:7]
v_and_b32_dpp v12, v30, v36 row_newbcast:5 row_mask:0xf bank_mask:0xf
v_and_b32_dpp v13, v30, v37 row_newbcast:5 row_mask:0xf bank_mask:0xf
v_and_b32_dpp v14, v30, v38 row_newbcast:5 row_mask:0xf bank_mask:0xf
v_and_b32_dpp v15, v30, v39 row_newbcast:5 row_mask:0xf bank_mask:0xf
v_mfma_f32_16x16x32_bf16 v[4:7], v[8:11], v[144:147], v[4:7]
v_and_b32_dpp v8, v30, v36 row_newbcast:6 row_mask:0xf bank_mask:0xf
v_and_b32_dpp v9, v30, v37 row_newbcast:6 row_mask:0xf bank_mask:0xf
v_and_b32_dpp v10, v30, v38 row_newbcast:6 row_mask:0xf bank_mask:0xf
v_and_b32_dpp v11, v30, v39 row_newbcast:6 row_mask:0xf bank_mask:0xf
v_mfma_f32_16x16x32_bf16 v[4:7], v[12:15], v[148:151], v[4:7]
v_and_b32_dpp v12, v30, v36 row_newbcast:7 row_mask:0xf bank_mask:0xf
v_and_b32_dpp v13, v30, v37 row_newbcast:7 row_mask:0xf bank_mask:0xf
v_and_b32_dpp v14, v30, v38 row_newbcast:7 row_mask:0xf bank_mask:0xf
v_and_b32_dpp v15, v30, v39 row_newbcast:7 row_mask:0xf bank_mask:0xf
v_mfma_f32_16x16x32_bf16 v[4:7], v[8:11], v[152:155], v[4:7]
v_and_b32_dpp v8, v30, v36 row_newbcast:8 row_mask:0xf bank_mask:0xf
v_and_b32_dpp v9, v30, v37 row_newbcast:8 row_mask:0xf bank_mask:0xf
v_and_b32_dpp v10, v30, v38 row_newbcast:8 row_mask:0xf bank_mask:0xf
v_and_b32_dpp v11, v30, v39 row_newbcast:8 row_mask:0xf bank_mask:0xf
v_mfma_f32_16x16x32_bf16 v[4:7], v[12:15], v[156:159], v[4:7]
s_waitcnt lgkmcnt(0)
v_readfirstlane_b32 s76, v18
ds_read_b32 v18, v17 offset:20
v_and_b32_dpp v12, v30, v36 row_newbcast:9 row_mask:0xf bank_mask:0xf
v_and_b32_dpp v13, v30, v37 row_newbcast:9 row_mask:0xf bank_mask:0xf
v_and_b32_dpp v14, v30, v38 row_newbcast:9 row_mask:0xf bank_mask:0xf
v_and_b32_dpp v15, v30, v39 row_newbcast:9 row_mask:0xf bank_mask:0xf
v_mfma_f32_16x16x32_bf16 v[4:7], v[8:11], v[160:163], v[4:7]
v_and_b32_dpp v8, v30, v36 row_newbcast:10 row_mask:0xf bank_mask:0xf
v_and_b32_dpp v9, v30, v37 row_newbcast:10 row_mask:0xf bank_mask:0xf
v_and_b32_dpp v10, v30, v38 row_newbcast:10 row_mask:0xf bank_mask:0xf
v_and_b32_dpp v11, v30, v39 row_newbcast:10 row_mask:0xf bank_mask:0xf
v_mfma_f32_16x16x32_bf16 v[4:7], v[12:15], v[164:167], v[4:7]
v_and_b32_dpp v12, v30, v36 row_newbcast:11 row_mask:0xf bank_mask:0xf
v_and_b32_dpp v13, v30, v37 row_newbcast:11 row_mask:0xf bank_mask:0xf
v_and_b32_dpp v14, v30, v38 row_newbcast:11 row_mask:0xf bank_mask:0xf
v_and_b32_dpp v15, v30, v39 row_newbcast:11 row_mask:0xf bank_mask:0xf
v_mfma_f32_16x16x32_bf16 v[4:7], v[8:11], v[168:171], v[4:7]
v_and_b32_dpp v8, v30, v36 row_newbcast:12 row_mask:0xf bank_mask:0xf
v_and_b32_dpp v9, v30, v37 row_newbcast:12 row_mask:0xf bank_mask:0xf
v_and_b32_dpp v10, v30, v38 row_newbcast:12 row_mask:0xf bank_mask:0xf
v_and_b32_dpp v11, v30, v39 row_newbcast:12 row_mask:0xf bank_mask:0xf
v_mfma_f32_16x16x32_bf16 v[4:7], v[12:15], v[172:175], v[4:7]
v_and_b32_dpp v12, v30, v36 row_newbcast:13 row_mask:0xf bank_mask:0xf
v_and_b32_dpp v13, v30, v37 row_newbcast:13 row_mask:0xf bank_mask:0xf
v_and_b32_dpp v14, v30, v38 row_newbcast:13 row_mask:0xf bank_mask:0xf
v_and_b32_dpp v15, v30, v39 row_newbcast:13 row_mask:0xf bank_mask:0xf
v_mfma_f32_16x16x32_bf16 v[4:7], v[8:11], v[176:179], v[4:7]
v_and_b32_dpp v8, v30, v36 row_newbcast:14 row_mask:0xf bank_mask:0xf
v_and_b32_dpp v9, v30, v37 row_newbcast:14 row_mask:0xf bank_mask:0xf
v_and_b32_dpp v10, v30, v38 row_newbcast:14 row_mask:0xf bank_mask:0xf
v_and_b32_dpp v11, v30, v39 row_newbcast:14 row_mask:0xf bank_mask:0xf
v_mfma_f32_16x16x32_bf16 v[4:7], v[12:15], v[180:183], v[4:7]
v_and_b32_dpp v12, v30, v36 row_newbcast:15 row_mask:0xf bank_mask:0xf
v_and_b32_dpp v13, v30, v37 row_newbcast:15 row_mask:0xf bank_mask:0xf
v_and_b32_dpp v14, v30, v38 row_newbcast:15 row_mask:0xf bank_mask:0xf
v_and_b32_dpp v15, v30, v39 row_newbcast:15 row_mask:0xf bank_mask:0xf
v_mfma_f32_16x16x32_bf16 v[4:7], v[8:11], v[184:187], v[4:7]
v_and_b32_dpp v8, v31, v36 row_newbcast:0 row_mask:0xf bank_mask:0xf
v_and_b32_dpp v9, v31, v37 row_newbcast:0 row_mask:0xf bank_mask:0xf
v_and_b32_dpp v10, v31, v38 row_newbcast:0 row_mask:0xf bank_mask:0xf
v_and_b32_dpp v11, v31, v39 row_newbcast:0 row_mask:0xf bank_mask:0xf
v_mfma_f32_16x16x32_bf16 v[4:7], v[12:15], v[188:191], v[4:7]
s_waitcnt lgkmcnt(0)
v_readfirstlane_b32 s76, v18
ds_read_b32 v18, v17 offset:20
v_and_b32_dpp v12, v31, v36 row_newbcast:1 row_mask:0xf bank_mask:0xf
v_and_b32_dpp v13, v31, v37 row_newbcast:1 row_mask:0xf bank_mask:0xf
v_and_b32_dpp v14, v31, v38 row_newbcast:1 row_mask:0xf bank_mask:0xf
v_and_b32_dpp v15, v31, v39 row_newbcast:1 row_mask:0xf bank_mask:0xf
v_mfma_f32_16x16x32_bf16 v[4:7], v[8:11], v[192:195], v[4:7]
v_and_b32_dpp v8, v31, v36 row_newbcast:2 row_mask:0xf bank_mask:0xf
v_and_b32_dpp v9, v31, v37 row_newbcast:2 row_mask:0xf bank_mask:0xf
v_and_b32_dpp v10, v31, v38 row_newbcast:2 row_mask:0xf bank_mask:0xf
v_and_b32_dpp v11, v31, v39 row_newbcast:2 row_mask:0xf bank_mask:0xf
v_mfma_f32_16x16x32_bf16 v[4:7], v[12:15], v[196:199], v[4:7]
v_and_b32_dpp v12, v31, v36 row_newbcast:3 row_mask:0xf bank_mask:0xf
v_and_b32_dpp v13, v31, v37 row_newbcast:3 row_mask:0xf bank_mask:0xf
v_and_b32_dpp v14, v31, v38 row_newbcast:3 row_mask:0xf bank_mask:0xf
v_and_b32_dpp v15, v31, v39 row_newbcast:3 row_mask:0xf bank_mask:0xf
v_mfma_f32_16x16x32_bf16 v[4:7], v[8:11], v[200:203], v[4:7]
v_and_b32_dpp v8, v31, v36 row_newbcast:4 row_mask:0xf bank_mask:0xf
v_and_b32_dpp v9, v31, v37 row_newbcast:4 row_mask:0xf bank_mask:0xf
v_and_b32_dpp v10, v31, v38 row_newbcast:4 row_mask:0xf bank_mask:0xf
v_and_b32_dpp v11, v31, v39 row_newbcast:4 row_mask:0xf bank_mask:0xf
v_mfma_f32_16x16x32_bf16 v[4:7], v[12:15], v[204:207], v[4:7]
v_and_b32_dpp v12, v31, v36 row_newbcast:5 row_mask:0xf bank_mask:0xf
v_and_b32_dpp v13, v31, v37 row_newbcast:5 row_mask:0xf bank_mask:0xf
v_and_b32_dpp v14, v31, v38 row_newbcast:5 row_mask:0xf bank_mask:0xf
v_and_b32_dpp v15, v31, v39 row_newbcast:5 row_mask:0xf bank_mask:0xf
v_mfma_f32_16x16x32_bf16 v[4:7], v[8:11], v[208:211], v[4:7]
v_and_b32_dpp v8, v31, v36 row_newbcast:6 row_mask:0xf bank_mask:0xf
v_and_b32_dpp v9, v31, v37 row_newbcast:6 row_mask:0xf bank_mask:0xf
v_and_b32_dpp v10, v31, v38 row_newbcast:6 row_mask:0xf bank_mask:0xf
v_and_b32_dpp v11, v31, v39 row_newbcast:6 row_mask:0xf bank_mask:0xf
v_mfma_f32_16x16x32_bf16 v[4:7], v[12:15], v[212:215], v[4:7]
v_and_b32_dpp v12, v31, v36 row_newbcast:7 row_mask:0xf bank_mask:0xf
v_and_b32_dpp v13, v31, v37 row_newbcast:7 row_mask:0xf bank_mask:0xf
v_and_b32_dpp v14, v31, v38 row_newbcast:7 row_mask:0xf bank_mask:0xf
v_and_b32_dpp v15, v31, v39 row_newbcast:7 row_mask:0xf bank_mask:0xf
v_mfma_f32_16x16x32_bf16 v[4:7], v[8:11], v[216:219], v[4:7]
v_and_b32_dpp v8, v31, v36 row_newbcast:8 row_mask:0xf bank_mask:0xf
v_and_b32_dpp v9, v31, v37 row_newbcast:8 row_mask:0xf bank_mask:0xf
v_and_b32_dpp v10, v31, v38 row_newbcast:8 row_mask:0xf bank_mask:0xf
v_and_b32_dpp v11, v31, v39 row_newbcast:8 row_mask:0xf bank_mask:0xf
v_mfma_f32_16x16x32_bf16 v[4:7], v[12:15], v[220:223], v[4:7]
s_waitcnt lgkmcnt(0)
v_readfirstlane_b32 s76, v18
ds_read_b32 v18, v17 offset:20
v_and_b32_dpp v12, v31, v36 row_newbcast:9 row_mask:0xf bank_mask:0xf
v_and_b32_dpp v13, v31, v37 row_newbcast:9 row_mask:0xf bank_mask:0xf
v_and_b32_dpp v14, v31, v38 row_newbcast:9 row_mask:0xf bank_mask:0xf
v_and_b32_dpp v15, v31, v39 row_newbcast:9 row_mask:0xf bank_mask:0xf
v_mfma_f32_16x16x32_bf16 v[4:7], v[8:11], v[224:227], v[4:7]
v_and_b32_dpp v8, v31, v36 row_newbcast:10 row_mask:0xf bank_mask:0xf
v_and_b32_dpp v9, v31, v37 row_newbcast:10 row_mask:0xf bank_mask:0xf
v_and_b32_dpp v10, v31, v38 row_newbcast:10 row_mask:0xf bank_mask:0xf
v_and_b32_dpp v11, v31, v39 row_newbcast:10 row_mask:0xf bank_mask:0xf
s_waitcnt vmcnt(6)
v_mfma_f32_16x16x32_bf16 v[4:7], v[12:15], v[228:231], v[4:7]
v_and_b32_dpp v12, v31, v36 row_newbcast:11 row_mask:0xf bank_mask:0xf
v_and_b32_dpp v13, v31, v37 row_newbcast:11 row_mask:0xf bank_mask:0xf
v_and_b32_dpp v14, v31, v38 row_newbcast:11 row_mask:0xf bank_mask:0xf
v_and_b32_dpp v15, v31, v39 row_newbcast:11 row_mask:0xf bank_mask:0xf
s_waitcnt vmcnt(5)
v_mfma_f32_16x16x32_bf16 v[4:7], v[8:11], v[232:235], v[4:7]
v_and_b32_dpp v8, v31, v36 row_newbcast:12 row_mask:0xf bank_mask:0xf
v_and_b32_dpp v9, v31, v37 row_newbcast:12 row_mask:0xf bank_mask:0xf
v_and_b32_dpp v10, v31, v38 row_newbcast:12 row_mask:0xf bank_mask:0xf
v_and_b32_dpp v11, v31, v39 row_newbcast:12 row_mask:0xf bank_mask:0xf
s_waitcnt vmcnt(4)
v_mfma_f32_16x16x32_bf16 v[4:7], v[12:15], v[236:239], v[4:7]
v_and_b32_dpp v12, v31, v36 row_newbcast:13 row_mask:0xf bank_mask:0xf
v_and_b32_dpp v13, v31, v37 row_newbcast:13 row_mask:0xf bank_mask:0xf
v_and_b32_dpp v14, v31, v38 row_newbcast:13 row_mask:0xf bank_mask:0xf
v_and_b32_dpp v15, v31, v39 row_newbcast:13 row_mask:0xf bank_mask:0xf
s_waitcnt vmcnt(3)
v_mfma_f32_16x16x32_bf16 v[4:7], v[8:11], v[240:243], v[4:7]
v_and_b32_dpp v8, v31, v36 row_newbcast:14 row_mask:0xf bank_mask:0xf
v_and_b32_dpp v9, v31, v37 row_newbcast:14 row_mask:0xf bank_mask:0xf
v_and_b32_dpp v10, v31, v38 row_newbcast:14 row_mask:0xf bank_mask:0xf
v_and_b32_dpp v11, v31, v39 row_newbcast:14 row_mask:0xf bank_mask:0xf
s_waitcnt vmcnt(2)
v_mfma_f32_16x16x32_bf16 v[4:7], v[12:15], v[244:247], v[4:7]
v_and_b32_dpp v12, v31, v36 row_newbcast:15 row_mask:0xf bank_mask:0xf
v_and_b32_dpp v13, v31, v37 row_newbcast:15 row_mask:0xf bank_mask:0xf
v_and_b32_dpp v14, v31, v38 row_newbcast:15 row_mask:0xf bank_mask:0xf
v_and_b32_dpp v15, v31, v39 row_newbcast:15 row_mask:0xf bank_mask:0xf
s_waitcnt vmcnt(1)
v_mfma_f32_16x16x32_bf16 v[4:7], v[8:11], v[248:251], v[4:7]
s_waitcnt vmcnt(0)
v_mfma_f32_16x16x32_bf16 v[4:7], v[12:15], v[252:255], v[4:7]
s_waitcnt lgkmcnt(0)
v_readfirstlane_b32 s76, v18
ds_read_b32 v18, v17 offset:20
s_waitcnt lgkmcnt(0)
s_nop 3
v_mul_f32 v4, v4, v50
v_mul_f32 v5, v5, v50
v_mul_f32 v6, v6, v50
v_mul_f32 v7, v7, v50
s_mov_b32 exec_hi, 0
ds_write_b128 v60, v[4:7] offset:4096
s_waitcnt lgkmcnt(0)
s_barrier
s_cmp_eq_u32 s3, 0
s_cbranch_scc0 L_sexit
ds_read_b128 v[128:131], v61 offset:4096
ds_read_b128 v[132:135], v61 offset:4608
ds_read_b128 v[136:139], v61 offset:5120
ds_read_b128 v[140:143], v61 offset:5632
s_waitcnt lgkmcnt(0)
v_pk_add_f32 v[128:129], v[128:129], v[132:133]
v_pk_add_f32 v[136:137], v[136:137], v[140:141]
v_pk_add_f32 v[128:129], v[128:129], v[136:137]
v_pk_add_f32 v[130:131], v[130:131], v[134:135]
v_pk_add_f32 v[138:139], v[138:139], v[142:143]
v_pk_add_f32 v[130:131], v[130:131], v[138:139]
v_and_or_b32 v128, v128, s14, v20
v_and_or_b32 v129, v129, s14, v21
v_and_or_b32 v130, v130, s14, v22
v_and_or_b32 v131, v131, s14, v23
global_store_dwordx4 v62, v[128:131], s[40:41] sc1
L_sexit:
s_mov_b32 exec_hi, -1
s_endpgm
L_H:
s_setprio 3
s_sub_u32 s71, s3, 4
s_lshl_b32 s72, s5, 1
s_add_u32 s72, s72, s6
v_and_b32 v44, 1, v35
v_cmp_eq_u32 vcc, 1, v44
v_mov_b32 v45, 0x0c0c0100
v_mov_b32 v46, 0x01000c0c
v_cndmask_b32 v47, v45, v46, vcc
v_mov_b32 v45, 0x0c0c0302
v_mov_b32 v46, 0x03020c0c
v_cndmask_b32 v48, v45, v46, vcc
v_bfe_u32 v44, v35, 1, 2
v_mov_b32 v45, 0x0c0c0c0c
v_cmp_gt_u32 s[12:13], 8, v35
v_cmp_eq_u32 vcc, 0, v44
s_nop 1
v_cndmask_b32 v16, v45, v47, vcc
v_cndmask_b32 v20, v45, v48, vcc
v_cndmask_b32 v24, v20, v16, s[12:13]
v_cmp_eq_u32 vcc, 1, v44
s_nop 1
v_cndmask_b32 v17, v45, v47, vcc
v_cndmask_b32 v21, v45, v48, vcc
v_cndmask_b32 v25, v21, v17, s[12:13]
v_cmp_eq_u32 vcc, 2, v44
s_nop 1
v_cndmask_b32 v18, v45, v47, vcc
v_cndmask_b32 v22, v45, v48, vcc
v_cndmask_b32 v26, v22, v18, s[12:13]
v_cmp_eq_u32 vcc, 3, v44
s_nop 1
v_cndmask_b32 v19, v45, v47, vcc
v_cndmask_b32 v23, v45, v48, vcc
v_cndmask_b32 v27, v23, v19, s[12:13]
s_lshr_b32 s8, s72, 1
s_mul_i32 s8, s8, 160
s_mul_i32 s9, s71, 40
s_add_u32 s8, s8, s9
v_mul_u32_u24 v44, 10, v34
v_add_u32 v44, s8, v44
v_lshlrev_b32 v46, 1, v44
v_lshrrev_b32 v45, 3, v35
v_add_u32 v45, v44, v45
v_lshlrev_b32 v45, 13, v45
v_and_b32 v47, 7, v35
v_lshlrev_b32 v47, 4, v47
v_add_u32 v48, v45, v47
s_waitcnt lgkmcnt(0)
s_or_b32 s8, s2, s71
s_cmp_eq_u32 s8, 0
s_cbranch_scc0 L_nononce
s_memrealtime s[8:9]
s_waitcnt lgkmcnt(0)
s_or_b32 s8, s8, 1
s_mul_i32 s8, s8, 0x9e3779b1
v_mov_b32 v44, 0
v_mov_b32 v50, s8
v_mov_b32 v51, 0
s_mov_b64 exec, 1
global_atomic_cmpswap v44, v[50:51], s[38:39]
s_mov_b64 exec, -1
L_nononce:
s_mov_b32 s44, s16
s_and_b32 s45, s17, 0xffff
s_mov_b32 s46, 5120
s_mov_b32 s47, 0x20000
s_lshl_b32 s8, s4, 8
s_and_b32 s9, s72, 1
s_lshl_b32 s9, s9, 7
s_add_u32 s8, s8, s9
s_add_u32 s48, s22, s8
s_addc_u32 s49, s23, 0
s_and_b32 s49, s49, 0xffff
s_sub_u32 s50, 5242880, s8
s_mov_b32 s51, 0x20000
s_mul_i32 s8, s71, 1280
v_lshlrev_b32 v44, 4, v1
v_add_u32 v45, s8, v44
s_add_u32 s9, s8, 57344
s_mov_b32 m0, s9
s_mov_b32 s60, s34
s_and_b32 s61, s35, 0xffff
s_mov_b32 s62, 1280
s_mov_b32 s63, 0x20000
buffer_load_dwordx4 v45, s[44:47], 0 offen lds
s_add_u32 m0, s9, 1024
s_mov_b32 s64, 1024
s_mov_b64 exec, 0xffff
buffer_load_dwordx4 v45, s[44:47], s64 offen lds
s_mov_b64 exec, -1
s_cmp_eq_u32 s71, 0
s_cbranch_scc0 L_nogw
s_mov_b32 m0, 62464
s_nop 0
buffer_load_dwordx4 v44, s[60:63], 0 offen lds
s_mov_b32 m0, 63488
s_mov_b64 exec, 0xffff
buffer_load_dwordx4 v44, s[60:63], s64 offen lds
s_mov_b64 exec, -1
L_nogw:
s_mov_b32 s64, 0
buffer_load_dwordx4 v[80:83], v48, s[48:51], s64 offen nt
s_mov_b32 s64, 16384
buffer_load_dwordx4 v[84:87], v48, s[48:51], s64 offen nt
s_mov_b32 s64, 32768
buffer_load_dwordx4 v[88:91], v48, s[48:51], s64 offen nt
s_mov_b32 s64, 49152
buffer_load_dwordx4 v[92:95], v48, s[48:51], s64 offen nt
s_mov_b32 s64, 65536
buffer_load_dwordx4 v[96:99], v48, s[48:51], s64 offen nt
s_waitcnt lgkmcnt(0)
s_waitcnt vmcnt(5)
s_waitcnt lgkmcnt(0)
v_mov_b32 v44, 0
v_mov_b32 v45, 1
s_mov_b64 exec, 1
ds_add_u32 v44, v45 offset:4
s_mov_b64 exec, -1
v_mov_b32 v44, 0
s_mov_b32 s73, 200000
L_sp163:
ds_read_b32 v45, v44 offset:4
s_waitcnt lgkmcnt(0)
v_readfirstlane_b32 s8, v45
s_cmp_ge_u32 s8, 4
s_cbranch_scc1 L_sp163_ok
s_sleep 1
s_sub_u32 s73, s73, 1
s_cbranch_scc0 L_sp163
L_sp163_ok:
v_add_u32 v100, 57344, v46
v_add_u32 v101, 58624, v46
v_add_u32 v102, 59904, v46
v_add_u32 v103, 61184, v46
ds_read2_b32 v[56:57], v100 offset0:0 offset1:1
ds_read2_b32 v[58:59], v100 offset0:2 offset1:3
ds_read_b32 v60, v100 offset:16
ds_read2_b32 v[62:63], v101 offset0:0 offset1:1
ds_read2_b32 v[64:65], v101 offset0:2 offset1:3
ds_read_b32 v66, v101 offset:16
ds_read2_b32 v[68:69], v102 offset0:0 offset1:1
ds_read2_b32 v[70:71], v102 offset0:2 offset1:3
ds_read_b32 v72, v102 offset:16
ds_read2_b32 v[74:75], v103 offset0:0 offset1:1
ds_read2_b32 v[76:77], v103 offset0:2 offset1:3
ds_read_b32 v78, v103 offset:16
s_cmp_eq_u32 s71, 0
s_cbranch_scc0 L_nopoll
v_mov_b32 v44, 0
s_mov_b32 s73, 200000
s_mov_b64 exec, 1
L_npoll:
global_load_dword v45, v44, s[38:39] sc1
s_waitcnt vmcnt(0)
v_readfirstlane_b32 s74, v45
s_cmp_lg_u32 s74, 0
s_cbranch_scc1 L_ngot
s_and_b32 s8, s73, 15
s_cmp_eq_u32 s8, 8
s_cbranch_scc0 L_nelect
s_memrealtime s[8:9]
s_waitcnt lgkmcnt(0)
s_or_b32 s8, s8, 1
s_mul_i32 s8, s8, 0x9e3779b1
v_mov_b32 v50, s8
v_mov_b32 v51, 0
global_atomic_cmpswap v44, v[50:51], s[38:39]
L_nelect:
s_sub_u32 s73, s73, 1
s_cbranch_scc0 L_npoll
L_ngot:
v_mov_b32 v45, s74
ds_write_b32 v44, v45 offset:32
s_mov_b64 exec, -1
L_nopoll:
s_waitcnt vmcnt(0) lgkmcnt(0)
v_perm_b32 v8, v56, v56, v24
v_perm_b32 v9, v56, v56, v25
v_perm_b32 v10, v56, v56, v26
v_perm_b32 v11, v56, v56, v27
s_nop 1
v_mfma_f32_16x16x32_bf16 v[4:7], v[8:11], v[80:83], 0
v_perm_b32 v12, v62, v62, v24
v_perm_b32 v13, v62, v62, v25
v_perm_b32 v14, v62, v62, v26
v_perm_b32 v15, v62, v62, v27
s_nop 1
v_mfma_f32_16x16x32_bf16 v[48:51], v[12:15], v[80:83], 0
v_perm_b32 v8, v68, v68, v24
v_perm_b32 v9, v68, v68, v25
v_perm_b32 v10, v68, v68, v26
v_perm_b32 v11, v68, v68, v27
s_nop 1
v_mfma_f32_16x16x32_bf16 v[52:55], v[8:11], v[80:83], 0
v_perm_b32 v12, v74, v74, v24
v_perm_b32 v13, v74, v74, v25
v_perm_b32 v14, v74, v74, v26
v_perm_b32 v15, v74, v74, v27
s_nop 1
v_mfma_f32_16x16x32_bf16 v[104:107], v[12:15], v[80:83], 0
v_perm_b32 v8, v57, v57, v24
v_perm_b32 v9, v57, v57, v25
v_perm_b32 v10, v57, v57, v26
v_perm_b32 v11, v57, v57, v27
s_nop 1
v_mfma_f32_16x16x32_bf16 v[4:7], v[8:11], v[84:87], v[4:7]
v_perm_b32 v12, v63, v63, v24
v_perm_b32 v13, v63, v63, v25
v_perm_b32 v14, v63, v63, v26
v_perm_b32 v15, v63, v63, v27
s_nop 1
v_mfma_f32_16x16x32_bf16 v[48:51], v[12:15], v[84:87], v[48:51]
v_perm_b32 v8, v69, v69, v24
v_perm_b32 v9, v69, v69, v25
v_perm_b32 v10, v69, v69, v26
v_perm_b32 v11, v69, v69, v27
s_nop 1
v_mfma_f32_16x16x32_bf16 v[52:55], v[8:11], v[84:87], v[52:55]
v_perm_b32 v12, v75, v75, v24
v_perm_b32 v13, v75, v75, v25
v_perm_b32 v14, v75, v75, v26
v_perm_b32 v15, v75, v75, v27
s_nop 1
v_mfma_f32_16x16x32_bf16 v[104:107], v[12:15], v[84:87], v[104:107]
v_perm_b32 v8, v58, v58, v24
v_perm_b32 v9, v58, v58, v25
v_perm_b32 v10, v58, v58, v26
v_perm_b32 v11, v58, v58, v27
s_nop 1
v_mfma_f32_16x16x32_bf16 v[4:7], v[8:11], v[88:91], v[4:7]
v_perm_b32 v12, v64, v64, v24
v_perm_b32 v13, v64, v64, v25
v_perm_b32 v14, v64, v64, v26
v_perm_b32 v15, v64, v64, v27
s_nop 1
v_mfma_f32_16x16x32_bf16 v[48:51], v[12:15], v[88:91], v[48:51]
v_perm_b32 v8, v70, v70, v24
v_perm_b32 v9, v70, v70, v25
v_perm_b32 v10, v70, v70, v26
v_perm_b32 v11, v70, v70, v27
s_nop 1
v_mfma_f32_16x16x32_bf16 v[52:55], v[8:11], v[88:91], v[52:55]
v_perm_b32 v12, v76, v76, v24
v_perm_b32 v13, v76, v76, v25
v_perm_b32 v14, v76, v76, v26
v_perm_b32 v15, v76, v76, v27
s_nop 1
v_mfma_f32_16x16x32_bf16 v[104:107], v[12:15], v[88:91], v[104:107]
v_perm_b32 v8, v59, v59, v24
v_perm_b32 v9, v59, v59, v25
v_perm_b32 v10, v59, v59, v26
v_perm_b32 v11, v59, v59, v27
s_nop 1
v_mfma_f32_16x16x32_bf16 v[4:7], v[8:11], v[92:95], v[4:7]
v_perm_b32 v12, v65, v65, v24
v_perm_b32 v13, v65, v65, v25
v_perm_b32 v14, v65, v65, v26
v_perm_b32 v15, v65, v65, v27
s_nop 1
v_mfma_f32_16x16x32_bf16 v[48:51], v[12:15], v[92:95], v[48:51]
v_perm_b32 v8, v71, v71, v24
v_perm_b32 v9, v71, v71, v25
v_perm_b32 v10, v71, v71, v26
v_perm_b32 v11, v71, v71, v27
s_nop 1
v_mfma_f32_16x16x32_bf16 v[52:55], v[8:11], v[92:95], v[52:55]
v_perm_b32 v12, v77, v77, v24
v_perm_b32 v13, v77, v77, v25
v_perm_b32 v14, v77, v77, v26
v_perm_b32 v15, v77, v77, v27
s_nop 1
v_mfma_f32_16x16x32_bf16 v[104:107], v[12:15], v[92:95], v[104:107]
v_perm_b32 v8, v60, v60, v24
v_perm_b32 v9, v60, v60, v25
v_perm_b32 v10, v60, v60, v26
v_perm_b32 v11, v60, v60, v27
s_nop 1
v_mfma_f32_16x16x32_bf16 v[4:7], v[8:11], v[96:99], v[4:7]
v_perm_b32 v12, v66, v66, v24
v_perm_b32 v13, v66, v66, v25
v_perm_b32 v14, v66, v66, v26
v_perm_b32 v15, v66, v66, v27
s_nop 1
v_mfma_f32_16x16x32_bf16 v[48:51], v[12:15], v[96:99], v[48:51]
v_perm_b32 v8, v72, v72, v24
v_perm_b32 v9, v72, v72, v25
v_perm_b32 v10, v72, v72, v26
v_perm_b32 v11, v72, v72, v27
s_nop 1
v_mfma_f32_16x16x32_bf16 v[52:55], v[8:11], v[96:99], v[52:55]
v_perm_b32 v12, v78, v78, v24
v_perm_b32 v13, v78, v78, v25
v_perm_b32 v14, v78, v78, v26
v_perm_b32 v15, v78, v78, v27
s_nop 1
v_mfma_f32_16x16x32_bf16 v[104:107], v[12:15], v[96:99], v[104:107]
s_lshl_b32 s8, s71, 11
v_lshrrev_b32 v45, 1, v34
v_lshlrev_b32 v45, 8, v45
v_and_b32 v46, 7, v35
v_lshlrev_b32 v46, 5, v46
v_add_u32 v45, v45, v46
v_and_b32 v46, 1, v34
v_lshlrev_b32 v46, 4, v46
v_add_u32 v45, v45, v46
v_add_u32 v45, s8, v45
s_mov_b32 exec_lo, 0x00ff00ff
s_mov_b32 exec_hi, 0xff00ff00
ds_write_b128 v45, v[4:7] offset:8192
ds_write_b128 v45, v[48:51] offset:8704
ds_write_b128 v45, v[52:55] offset:9216
ds_write_b128 v45, v[104:107] offset:9728
s_mov_b64 exec, -1
s_waitcnt lgkmcnt(0)
v_mov_b32 v44, 0
v_mov_b32 v45, 1
s_mov_b64 exec, 1
ds_add_u32 v44, v45 offset:4
s_mov_b64 exec, -1
v_mov_b32 v44, 0
s_mov_b32 s73, 200000
L_sp164:
ds_read_b32 v45, v44 offset:4
s_waitcnt lgkmcnt(0)
v_readfirstlane_b32 s8, v45
s_cmp_ge_u32 s8, 8
s_cbranch_scc1 L_sp164_ok
s_sleep 1
s_sub_u32 s73, s73, 1
s_cbranch_scc0 L_sp164
L_sp164_ok:
v_mov_b32 v44, 0
ds_read_b32 v32, v44 offset:32
s_lshl_b32 s8, s71, 9
v_lshlrev_b32 v45, 4, v35
v_add_u32 v45, s8, v45
ds_read_b128 v[56:59], v45 offset:8192
ds_read_b128 v[60:63], v45 offset:8448
ds_read_b128 v[64:67], v45 offset:10240
ds_read_b128 v[68:71], v45 offset:10496
ds_read_b128 v[72:75], v45 offset:12288
ds_read_b128 v[76:79], v45 offset:12544
ds_read_b128 v[80:83], v45 offset:14336
ds_read_b128 v[84:87], v45 offset:14592
s_lshl_b32 s10, s4, 3
s_add_u32 s10, s10, s72
s_lshl_b32 s10, s10, 2
s_add_u32 s10, s10, s71
s_lshl_b32 s10, s10, 8
s_add_u32 s10, s10, 65536
v_lshlrev_b32 v46, 4, v35
v_add_u32 v46, s10, v46
s_waitcnt lgkmcnt(0)
v_readfirstlane_b32 s74, v32
s_mov_b32 s14, 0xffffff00
v_and_b32 v28, 0xff, v32
v_bfe_u32 v29, v32, 8, 8
v_bfe_u32 v30, v32, 16, 8
v_bfe_u32 v31, v32, 24, 8
v_pk_add_f32 v[56:57], v[56:57], v[60:61]
v_pk_add_f32 v[58:59], v[58:59], v[62:63]
v_pk_add_f32 v[64:65], v[64:65], v[68:69]
v_pk_add_f32 v[66:67], v[66:67], v[70:71]
v_pk_add_f32 v[72:73], v[72:73], v[76:77]
v_pk_add_f32 v[74:75], v[74:75], v[78:79]
v_pk_add_f32 v[80:81], v[80:81], v[84:85]
v_pk_add_f32 v[82:83], v[82:83], v[86:87]
v_pk_add_f32 v[56:57], v[56:57], v[64:65]
v_pk_add_f32 v[58:59], v[58:59], v[66:67]
v_pk_add_f32 v[72:73], v[72:73], v[80:81]
v_pk_add_f32 v[74:75], v[74:75], v[82:83]
v_pk_add_f32 v[56:57], v[56:57], v[72:73]
v_pk_add_f32 v[58:59], v[58:59], v[74:75]
v_and_or_b32 v56, v56, s14, v28
v_and_or_b32 v57, v57, s14, v29
v_and_or_b32 v58, v58, s14, v30
v_and_or_b32 v59, v59, s14, v31
s_mov_b64 exec, 0xffff
global_store_dwordx4 v46, v[56:59], s[40:41] sc1
s_mov_b64 exec, -1
s_cmp_eq_u32 s71, 0
s_cbranch_scc0 L_noq
s_lshl_b32 s10, s4, 5
s_add_u32 s10, s10, s5
s_lshl_b32 s10, s10, 8
s_add_u32 s10, s10, 65536
v_lshlrev_b32 v46, 11, v34
v_lshlrev_b32 v47, 4, v35
v_add_u32 v46, v46, v47
v_add_u32 v46, s10, v46
s_mov_b32 s73, 200000
L_qpoll:
s_sleep 16
global_load_dwordx4 v[56:59], v46, s[40:41] sc1
global_load_dwordx4 v[60:63], v46, s[40:41] offset:1024 sc1
s_waitcnt vmcnt(0)
s_mov_b32 s12, 0x0c0c0400
s_mov_b32 s13, 0x04000c0c
v_perm_b32 v44, v57, v56, s12
v_perm_b32 v45, v59, v58, s13
v_or_b32 v44, v44, v45
v_cmp_ne_u32 s[78:79], s74, v44
v_perm_b32 v44, v61, v60, s12
v_perm_b32 v45, v63, v62, s13
v_or_b32 v44, v44, v45
v_cmp_ne_u32 vcc, s74, v44
s_or_b64 s[78:79], s[78:79], vcc
s_cmp_eq_u64 s[78:79], 0
s_cbranch_scc1 L_qok
s_sub_u32 s73, s73, 1
s_cbranch_scc0 L_qpoll
L_qok:
v_mov_b32 v88, v56
v_mov_b32 v89, v57
v_mov_b32 v90, v58
v_mov_b32 v91, v59
v_mov_b32 v92, v60
v_mov_b32 v93, v61
v_mov_b32 v94, v62
v_mov_b32 v95, v63
v_permlane16_swap_b32 v56, v88
v_permlane16_swap_b32 v57, v89
v_permlane16_swap_b32 v58, v90
v_permlane16_swap_b32 v59, v91
v_permlane16_swap_b32 v60, v92
v_permlane16_swap_b32 v61, v93
v_permlane16_swap_b32 v62, v94
v_permlane16_swap_b32 v63, v95
v_add_f32 v56, v56, v88
v_add_f32 v57, v57, v89
v_add_f32 v58, v58, v90
v_add_f32 v59, v59, v91
v_add_f32 v60, v60, v92
v_add_f32 v61, v61, v93
v_add_f32 v62, v62, v94
v_add_f32 v63, v63, v95
v_mov_b32 v88, v56
v_mov_b32 v89, v57
v_mov_b32 v90, v58
v_mov_b32 v91, v59
v_mov_b32 v92, v60
v_mov_b32 v93, v61
v_mov_b32 v94, v62
v_mov_b32 v95, v63
v_permlane32_swap_b32 v56, v88
v_permlane32_swap_b32 v57, v89
v_permlane32_swap_b32 v58, v90
v_permlane32_swap_b32 v59, v91
v_permlane32_swap_b32 v60, v92
v_permlane32_swap_b32 v61, v93
v_permlane32_swap_b32 v62, v94
v_permlane32_swap_b32 v63, v95
v_add_f32 v56, v56, v88
v_add_f32 v57, v57, v89
v_add_f32 v58, v58, v90
v_add_f32 v59, v59, v91
v_add_f32 v60, v60, v92
v_add_f32 v61, v61, v93
v_add_f32 v62, v62, v94
v_add_f32 v63, v63, v95
v_cvt_pk_bf16_f32 v56, v56, v57
v_cvt_pk_bf16_f32 v57, v58, v59
v_cvt_pk_bf16_f32 v58, v60, v61
v_cvt_pk_bf16_f32 v59, v62, v63
v_lshlrev_b32 v45, 3, v35
v_mov_b32 v44, 0
v_mov_b32 v47, 1
s_mov_b64 exec, 0xffff
ds_write_b64 v45, v[56:57] offset:128
ds_write_b64 v45, v[58:59] offset:256
s_mov_b64 exec, 1
ds_write_b32 v44, v47 offset:12
s_mov_b64 exec, -1
L_noq:
s_setprio 0
s_lshr_b32 s8, s2, 3
s_and_b32 s9, s8, 3
s_lshl_b32 s9, s9, 1
s_add_u32 s9, s9, 1
s_and_b32 s10, s2, 7
s_mul_i32 s8, s8, 7
s_add_u32 s8, s8, s10
s_cmp_gt_u32 s10, s9
s_cselect_b32 s11, 1, 0
s_sub_u32 s8, s8, s11
s_lshr_b32 s76, s8, 3
s_and_b32 s77, s8, 7
s_cmp_lt_u32 s8, 216
s_cselect_b32 s75, 1, 0
s_cmp_eq_u32 s10, s9
s_cselect_b32 s75, 0, s75
s_cmp_ge_u32 s72, 1
s_cselect_b32 s66, 1, 0
s_add_u32 s66, s66, s72
s_cmp_ge_u32 s72, 5
s_addc_u32 s66, s66, 0
s_lshl_b32 s66, s66, 7
s_and_b32 s67, s72, 3
s_cmp_eq_u32 s67, 0
s_cselect_b32 s67, 16, 8
s_cselect_b32 s68, -1, 0xffff
s_cmp_ge_u32 s77, 1
s_cselect_b32 s65, 1, 0
s_add_u32 s65, s65, s77
s_cmp_ge_u32 s77, 5
s_addc_u32 s65, s65, 0
s_lshl_b32 s65, s65, 7
s_and_b32 s69, s77, 3
s_cmp_eq_u32 s69, 0
s_cselect_b32 s69, 16, 8
s_cselect_b32 s70, -1, 0xffff
s_mul_i32 s8, s4, 163840
s_add_u32 s8, s8, s66
s_add_u32 s48, s24, s8
s_addc_u32 s49, s25, 0
s_and_b32 s49, s49, 0xffff
s_sub_u32 s50, 5242880, s8
s_mov_b32 s51, 0x20000
v_mul_u32_u24 v46, 2560, v34
v_lshlrev_b32 v47, 4, v35
v_add_u32 v46, v46, v47
s_mul_i32 s8, s71, 40960
v_add_u32 v46, s8, v46
v_mov_b32 v47, 0x7ff00000
v_cmp_gt_u32 vcc, s67, v35
s_nop 1
v_cndmask_b32 v46, v47, v46, vcc
s_lshl_b32 s9, s71, 13
s_add_u32 s9, s9, 16384
s_add_u32 m0, s9, 0
s_mov_b32 s64, 0
buffer_load_dwordx4 v46, s[48:51], s64 offen nt lds
s_add_u32 m0, s9, 1024
s_mov_b32 s64, 1280
buffer_load_dwordx4 v46, s[48:51], s64 offen nt lds
s_add_u32 m0, s9, 2048
s_mov_b32 s64, 10240
buffer_load_dwordx4 v46, s[48:51], s64 offen nt lds
s_add_u32 m0, s9, 3072
s_mov_b32 s64, 11520
buffer_load_dwordx4 v46, s[48:51], s64 offen nt lds
s_add_u32 m0, s9, 4096
s_mov_b32 s64, 20480
buffer_load_dwordx4 v46, s[48:51], s64 offen nt lds
s_add_u32 m0, s9, 5120
s_mov_b32 s64, 21760
buffer_load_dwordx4 v46, s[48:51], s64 offen nt lds
s_add_u32 m0, s9, 6144
s_mov_b32 s64, 30720
buffer_load_dwordx4 v46, s[48:51], s64 offen nt lds
s_add_u32 m0, s9, 7168
s_mov_b32 s64, 32000
buffer_load_dwordx4 v46, s[48:51], s64 offen nt lds
s_cmp_eq_u32 s75, 1
s_cbranch_scc0 L_nobulk
s_and_b32 s8, s77, 1
s_cmp_eq_u32 s8, 0
s_cselect_b32 s60, s28, s30
s_cselect_b32 s61, s29, s31
s_lshl_b32 s8, s76, 7
s_add_u32 s60, s60, s8
s_addc_u32 s61, s61, 0
s_and_b32 s61, s61, 0xffff
s_sub_u32 s62, 2211840, s8
s_mov_b32 s63, 0x20000
s_lshr_b32 s8, s77, 1
s_mul_i32 s8, s8, 160
s_mul_i32 s9, s71, 40
s_add_u32 s8, s8, s9
v_mul_u32_u24 v44, 10, v34
v_add_u32 v44, s8, v44
v_lshlrev_b32 v41, 1, v44
v_lshrrev_b32 v45, 3, v35
v_add_u32 v45, v44, v45
v_mul_u32_u24 v45, 3456, v45
v_and_b32 v47, 7, v35
v_lshlrev_b32 v47, 4, v47
v_add_u32 v45, v45, v47
s_mov_b32 s64, 0
buffer_load_dwordx4 v[96:99], v45, s[60:63], s64 offen nt
s_mov_b32 s64, 6912
buffer_load_dwordx4 v[100:103], v45, s[60:63], s64 offen nt
s_mov_b32 s64, 13824
buffer_load_dwordx4 v[104:107], v45, s[60:63], s64 offen nt
s_mov_b32 s64, 20736
buffer_load_dwordx4 v[108:111], v45, s[60:63], s64 offen nt
s_mov_b32 s64, 27648
buffer_load_dwordx4 v[112:115], v45, s[60:63], s64 offen nt
s_lshl_b32 s8, s76, 6
s_lshl_b32 s9, s71, 4
s_add_u32 s8, s8, s9
s_mul_i32 s8, s8, 1280
s_add_u32 s8, s8, s65
s_add_u32 s60, s32, s8
s_addc_u32 s61, s33, 0
s_and_b32 s61, s61, 0xffff
s_sub_u32 s62, 2211840, s8
s_mov_b32 s63, 0x20000
v_mul_u32_u24 v46, 2560, v34
v_lshlrev_b32 v47, 4, v35
v_add_u32 v46, v46, v47
v_mov_b32 v47, 0x7ff00000
v_cmp_gt_u32 vcc, s69, v35
s_nop 1
v_cndmask_b32 v46, v47, v46, vcc
s_mov_b32 s64, 0
buffer_load_dwordx4 v[120:123], v46, s[60:63], s64 offen nt
s_mov_b32 s64, 1280
buffer_load_dwordx4 v[124:127], v46, s[60:63], s64 offen nt
s_mov_b32 s64, 10240
buffer_load_dwordx4 v[128:131], v46, s[60:63], s64 offen nt
s_mov_b32 s64, 11520
buffer_load_dwordx4 v[132:135], v46, s[60:63], s64 offen nt
L_nobulk:
s_waitcnt vmcnt(0)
v_mul_u32_u24 v44, 20, v1
s_mul_i32 s8, s71, 1280
s_add_u32 s8, s8, 57344
v_add_u32 v45, s8, v44
v_add_u32 v44, 62464, v44
ds_read2_b32 v[36:37], v45 offset0:0 offset1:1
ds_read2_b32 v[38:39], v45 offset0:2 offset1:3
ds_read_b32 v40, v45 offset:16
ds_read2_b32 v[48:49], v44 offset0:0 offset1:1
ds_read2_b32 v[50:51], v44 offset0:2 offset1:3
ds_read_b32 v52, v44 offset:16
s_waitcnt lgkmcnt(0)
v_dot2_f32_bf16 v33, v36, v48, 0
v_dot2_f32_bf16 v33, v37, v49, v33
v_dot2_f32_bf16 v33, v38, v50, v33
v_dot2_f32_bf16 v33, v39, v51, v33
v_dot2_f32_bf16 v33, v40, v52, v33
s_nop 2
v_add_f32_dpp v33, v33, v33 row_ror:8 row_mask:0xf bank_mask:0xf
s_nop 1
v_add_f32_dpp v33, v33, v33 row_ror:4 row_mask:0xf bank_mask:0xf
s_nop 1
v_add_f32_dpp v33, v33, v33 quad_perm:[2,3,0,1] row_mask:0xf bank_mask:0xf
s_nop 1
v_add_f32_dpp v33, v33, v33 quad_perm:[1,0,3,2] row_mask:0xf bank_mask:0xf
s_nop 0
v_readlane_b32 s8, v33, 0
v_readlane_b32 s9, v33, 16
v_readlane_b32 s10, v33, 32
v_readlane_b32 s11, v33, 48
v_mov_b32 v33, s8
v_add_f32 v33, s9, v33
v_add_f32 v33, s10, v33
v_add_f32 v33, s11, v33
v_mul_f32 v33, 0xbfb8aa3b, v33
v_exp_f32 v33, v33
s_nop 0
v_add_f32 v33, 1.0, v33
v_rcp_f32 v33, v33
s_nop 0
v_sub_f32 v32, 1.0, v33
s_setprio 0
s_waitcnt lgkmcnt(0)
v_mov_b32 v44, 0
v_mov_b32 v45, 1
s_mov_b64 exec, 1
ds_add_u32 v44, v45 offset:4
s_mov_b64 exec, -1
v_mov_b32 v44, 0
s_mov_b32 s73, 200000
L_sp165:
ds_read_b32 v45, v44 offset:4
s_waitcnt lgkmcnt(0)
v_readfirstlane_b32 s8, v45
s_cmp_ge_u32 s8, 12
s_cbranch_scc1 L_sp165_ok
s_sleep 2
s_sub_u32 s73, s73, 1
s_cbranch_scc0 L_sp165
L_sp165_ok:
s_cmp_eq_u32 s75, 1
s_cbranch_scc0 L_noffn
v_add_u32 v116, 57344, v41
v_add_u32 v117, 58624, v41
v_add_u32 v118, 59904, v41
v_add_u32 v119, 61184, v41
ds_read2_b32 v[56:57], v116 offset0:0 offset1:1
ds_read2_b32 v[58:59], v116 offset0:2 offset1:3
ds_read_b32 v60, v116 offset:16
ds_read2_b32 v[62:63], v117 offset0:0 offset1:1
ds_read2_b32 v[64:65], v117 offset0:2 offset1:3
ds_read_b32 v66, v117 offset:16
ds_read2_b32 v[68:69], v118 offset0:0 offset1:1
ds_read2_b32 v[70:71], v118 offset0:2 offset1:3
ds_read_b32 v72, v118 offset:16
ds_read2_b32 v[74:75], v119 offset0:0 offset1:1
ds_read2_b32 v[76:77], v119 offset0:2 offset1:3
ds_read_b32 v78, v119 offset:16
s_waitcnt lgkmcnt(0)
v_perm_b32 v8, v56, v56, v24
v_perm_b32 v9, v56, v56, v25
v_perm_b32 v10, v56, v56, v26
v_perm_b32 v11, v56, v56, v27
s_nop 1
v_mfma_f32_16x16x32_bf16 v[4:7], v[8:11], v[96:99], 0
v_perm_b32 v12, v62, v62, v24
v_perm_b32 v13, v62, v62, v25
v_perm_b32 v14, v62, v62, v26
v_perm_b32 v15, v62, v62, v27
s_nop 1
v_mfma_f32_16x16x32_bf16 v[48:51], v[12:15], v[96:99], 0
v_perm_b32 v8, v68, v68, v24
v_perm_b32 v9, v68, v68, v25
v_perm_b32 v10, v68, v68, v26
v_perm_b32 v11, v68, v68, v27
s_nop 1
v_mfma_f32_16x16x32_bf16 v[52:55], v[8:11], v[96:99], 0
v_perm_b32 v12, v74, v74, v24
v_perm_b32 v13, v74, v74, v25
v_perm_b32 v14, v74, v74, v26
v_perm_b32 v15, v74, v74, v27
s_nop 1
v_mfma_f32_16x16x32_bf16 v[80:83], v[12:15], v[96:99], 0
v_perm_b32 v8, v57, v57, v24
v_perm_b32 v9, v57, v57, v25
v_perm_b32 v10, v57, v57, v26
v_perm_b32 v11, v57, v57, v27
s_nop 1
v_mfma_f32_16x16x32_bf16 v[4:7], v[8:11], v[100:103], v[4:7]
v_perm_b32 v12, v63, v63, v24
v_perm_b32 v13, v63, v63, v25
v_perm_b32 v14, v63, v63, v26
v_perm_b32 v15, v63, v63, v27
s_nop 1
v_mfma_f32_16x16x32_bf16 v[48:51], v[12:15], v[100:103], v[48:51]
v_perm_b32 v8, v69, v69, v24
v_perm_b32 v9, v69, v69, v25
v_perm_b32 v10, v69, v69, v26
v_perm_b32 v11, v69, v69, v27
s_nop 1
v_mfma_f32_16x16x32_bf16 v[52:55], v[8:11], v[100:103], v[52:55]
v_perm_b32 v12, v75, v75, v24
v_perm_b32 v13, v75, v75, v25
v_perm_b32 v14, v75, v75, v26
v_perm_b32 v15, v75, v75, v27
s_nop 1
v_mfma_f32_16x16x32_bf16 v[80:83], v[12:15], v[100:103], v[80:83]
v_perm_b32 v8, v58, v58, v24
v_perm_b32 v9, v58, v58, v25
v_perm_b32 v10, v58, v58, v26
v_perm_b32 v11, v58, v58, v27
s_nop 1
v_mfma_f32_16x16x32_bf16 v[4:7], v[8:11], v[104:107], v[4:7]
v_perm_b32 v12, v64, v64, v24
v_perm_b32 v13, v64, v64, v25
v_perm_b32 v14, v64, v64, v26
v_perm_b32 v15, v64, v64, v27
s_nop 1
v_mfma_f32_16x16x32_bf16 v[48:51], v[12:15], v[104:107], v[48:51]
v_perm_b32 v8, v70, v70, v24
v_perm_b32 v9, v70, v70, v25
v_perm_b32 v10, v70, v70, v26
v_perm_b32 v11, v70, v70, v27
s_nop 1
v_mfma_f32_16x16x32_bf16 v[52:55], v[8:11], v[104:107], v[52:55]
v_perm_b32 v12, v76, v76, v24
v_perm_b32 v13, v76, v76, v25
v_perm_b32 v14, v76, v76, v26
v_perm_b32 v15, v76, v76, v27
s_nop 1
v_mfma_f32_16x16x32_bf16 v[80:83], v[12:15], v[104:107], v[80:83]
v_perm_b32 v8, v59, v59, v24
v_perm_b32 v9, v59, v59, v25
v_perm_b32 v10, v59, v59, v26
v_perm_b32 v11, v59, v59, v27
s_nop 1
v_mfma_f32_16x16x32_bf16 v[4:7], v[8:11], v[108:111], v[4:7]
v_perm_b32 v12, v65, v65, v24
v_perm_b32 v13, v65, v65, v25
v_perm_b32 v14, v65, v65, v26
v_perm_b32 v15, v65, v65, v27
s_nop 1
v_mfma_f32_16x16x32_bf16 v[48:51], v[12:15], v[108:111], v[48:51]
v_perm_b32 v8, v71, v71, v24
v_perm_b32 v9, v71, v71, v25
v_perm_b32 v10, v71, v71, v26
v_perm_b32 v11, v71, v71, v27
s_nop 1
v_mfma_f32_16x16x32_bf16 v[52:55], v[8:11], v[108:111], v[52:55]
v_perm_b32 v12, v77, v77, v24
v_perm_b32 v13, v77, v77, v25
v_perm_b32 v14, v77, v77, v26
v_perm_b32 v15, v77, v77, v27
s_nop 1
v_mfma_f32_16x16x32_bf16 v[80:83], v[12:15], v[108:111], v[80:83]
v_perm_b32 v8, v60, v60, v24
v_perm_b32 v9, v60, v60, v25
v_perm_b32 v10, v60, v60, v26
v_perm_b32 v11, v60, v60, v27
s_nop 1
v_mfma_f32_16x16x32_bf16 v[4:7], v[8:11], v[112:115], v[4:7]
v_perm_b32 v12, v66, v66, v24
v_perm_b32 v13, v66, v66, v25
v_perm_b32 v14, v66, v66, v26
v_perm_b32 v15, v66, v66, v27
s_nop 1
v_mfma_f32_16x16x32_bf16 v[48:51], v[12:15], v[112:115], v[48:51]
v_perm_b32 v8, v72, v72, v24
v_perm_b32 v9, v72, v72, v25
v_perm_b32 v10, v72, v72, v26
v_perm_b32 v11, v72, v72, v27
s_nop 1
v_mfma_f32_16x16x32_bf16 v[52:55], v[8:11], v[112:115], v[52:55]
v_perm_b32 v12, v78, v78, v24
v_perm_b32 v13, v78, v78, v25
v_perm_b32 v14, v78, v78, v26
v_perm_b32 v15, v78, v78, v27
s_nop 1
v_mfma_f32_16x16x32_bf16 v[80:83], v[12:15], v[112:115], v[80:83]
s_lshl_b32 s8, s71, 11
v_lshrrev_b32 v45, 1, v34
v_lshlrev_b32 v45, 8, v45
v_and_b32 v46, 7, v35
v_lshlrev_b32 v46, 5, v46
v_add_u32 v45, v45, v46
v_and_b32 v46, 1, v34
v_lshlrev_b32 v46, 4, v46
v_add_u32 v45, v45, v46
v_add_u32 v45, s8, v45
s_mov_b32 exec_lo, 0x00ff00ff
s_mov_b32 exec_hi, 0xff00ff00
ds_write_b128 v45, v[4:7] offset:8192
ds_write_b128 v45, v[48:51] offset:8704
ds_write_b128 v45, v[52:55] offset:9216
ds_write_b128 v45, v[80:83] offset:9728
s_mov_b64 exec, -1
s_waitcnt lgkmcnt(0)
v_mov_b32 v44, 0
v_mov_b32 v45, 1
s_mov_b64 exec, 1
ds_add_u32 v44, v45 offset:4
s_mov_b64 exec, -1
v_mov_b32 v44, 0
s_mov_b32 s73, 200000
L_sp166:
ds_read_b32 v45, v44 offset:4
s_waitcnt lgkmcnt(0)
v_readfirstlane_b32 s8, v45
s_cmp_ge_u32 s8, 16
s_cbranch_scc1 L_sp166_ok
s_sleep 1
s_sub_u32 s73, s73, 1
s_cbranch_scc0 L_sp166
L_sp166_ok:
s_lshl_b32 s8, s71, 9
v_lshlrev_b32 v45, 4, v35
v_add_u32 v45, s8, v45
ds_read_b128 v[56:59], v45 offset:8192
ds_read_b128 v[60:63], v45 offset:8448
ds_read_b128 v[64:67], v45 offset:10240
ds_read_b128 v[68:71], v45 offset:10496
ds_read_b128 v[72:75], v45 offset:12288
ds_read_b128 v[76:79], v45 offset:12544
ds_read_b128 v[80:83], v45 offset:14336
ds_read_b128 v[84:87], v45 offset:14592
s_lshl_b32 s10, s76, 3
s_add_u32 s10, s10, s77
s_lshl_b32 s10, s10, 2
s_add_u32 s10, s10, s71
s_lshl_b32 s10, s10, 8
s_add_u32 s10, s10, 327680
v_lshlrev_b32 v46, 4, v35
v_add_u32 v46, s10, v46
s_waitcnt lgkmcnt(0)
v_pk_add_f32 v[56:57], v[56:57], v[60:61]
v_pk_add_f32 v[58:59], v[58:59], v[62:63]
v_pk_add_f32 v[64:65], v[64:65], v[68:69]
v_pk_add_f32 v[66:67], v[66:67], v[70:71]
v_pk_add_f32 v[72:73], v[72:73], v[76:77]
v_pk_add_f32 v[74:75], v[74:75], v[78:79]
v_pk_add_f32 v[80:81], v[80:81], v[84:85]
v_pk_add_f32 v[82:83], v[82:83], v[86:87]
v_pk_add_f32 v[56:57], v[56:57], v[64:65]
v_pk_add_f32 v[58:59], v[58:59], v[66:67]
v_pk_add_f32 v[72:73], v[72:73], v[80:81]
v_pk_add_f32 v[74:75], v[74:75], v[82:83]
v_pk_add_f32 v[56:57], v[56:57], v[72:73]
v_pk_add_f32 v[58:59], v[58:59], v[74:75]
v_and_or_b32 v56, v56, s14, v28
v_and_or_b32 v57, v57, s14, v29
v_and_or_b32 v58, v58, s14, v30
v_and_or_b32 v59, v59, s14, v31
s_mov_b64 exec, 0xffff
global_store_dwordx4 v46, v[56:59], s[40:41] sc1
s_mov_b64 exec, -1
s_lshl_b32 s10, s76, 5
s_add_u32 s10, s10, s71
s_lshl_b32 s10, s10, 8
s_add_u32 s10, s10, 327680
v_lshlrev_b32 v46, 11, v34
v_lshlrev_b32 v47, 4, v35
v_add_u32 v46, v46, v47
v_add_u32 v46, s10, v46
s_mov_b32 s73, 200000
L_fpoll:
s_sleep 48
global_load_dwordx4 v[60:63], v46, s[40:41] offset:1024 sc1
global_load_dwordx4 v[56:59], v46, s[40:41] sc1
s_waitcnt vmcnt(0)
s_mov_b32 s12, 0x0c0c0400
s_mov_b32 s13, 0x04000c0c
v_perm_b32 v44, v57, v56, s12
v_perm_b32 v45, v59, v58, s13
v_or_b32 v44, v44, v45
v_cmp_ne_u32 s[78:79], s74, v44
v_perm_b32 v44, v61, v60, s12
v_perm_b32 v45, v63, v62, s13
v_or_b32 v44, v44, v45
v_cmp_ne_u32 vcc, s74, v44
s_or_b64 s[78:79], s[78:79], vcc
s_cmp_eq_u64 s[78:79], 0
s_cbranch_scc1 L_fok
s_sub_u32 s73, s73, 1
s_cbranch_scc0 L_fpoll
L_fok:
v_mov_b32 v88, v56
v_mov_b32 v89, v57
v_mov_b32 v90, v58
v_mov_b32 v91, v59
v_mov_b32 v92, v60
v_mov_b32 v93, v61
v_mov_b32 v94, v62
v_mov_b32 v95, v63
v_permlane16_swap_b32 v56, v88
v_permlane16_swap_b32 v57, v89
v_permlane16_swap_b32 v58, v90
v_permlane16_swap_b32 v59, v91
v_permlane16_swap_b32 v60, v92
v_permlane16_swap_b32 v61, v93
v_permlane16_swap_b32 v62, v94
v_permlane16_swap_b32 v63, v95
v_add_f32 v56, v56, v88
v_add_f32 v57, v57, v89
v_add_f32 v58, v58, v90
v_add_f32 v59, v59, v91
v_add_f32 v60, v60, v92
v_add_f32 v61, v61, v93
v_add_f32 v62, v62, v94
v_add_f32 v63, v63, v95
v_mov_b32 v88, v56
v_mov_b32 v89, v57
v_mov_b32 v90, v58
v_mov_b32 v91, v59
v_mov_b32 v92, v60
v_mov_b32 v93, v61
v_mov_b32 v94, v62
v_mov_b32 v95, v63
v_permlane32_swap_b32 v56, v88
v_permlane32_swap_b32 v57, v89
v_permlane32_swap_b32 v58, v90
v_permlane32_swap_b32 v59, v91
v_permlane32_swap_b32 v60, v92
v_permlane32_swap_b32 v61, v93
v_permlane32_swap_b32 v62, v94
v_permlane32_swap_b32 v63, v95
v_add_f32 v56, v56, v88
v_add_f32 v57, v57, v89
v_add_f32 v58, v58, v90
v_add_f32 v59, v59, v91
v_add_f32 v60, v60, v92
v_add_f32 v61, v61, v93
v_add_f32 v62, v62, v94
v_add_f32 v63, v63, v95
v_mul_f32 v64, 0xbfb8aa3b, v56
v_mul_f32 v65, 0xbfb8aa3b, v57
v_mul_f32 v66, 0xbfb8aa3b, v58
v_mul_f32 v67, 0xbfb8aa3b, v59
v_exp_f32 v64, v64
v_exp_f32 v65, v65
v_exp_f32 v66, v66
v_exp_f32 v67, v67
v_add_f32 v64, 1.0, v64
v_add_f32 v65, 1.0, v65
v_add_f32 v66, 1.0, v66
v_add_f32 v67, 1.0, v67
v_rcp_f32 v64, v64
v_rcp_f32 v65, v65
v_rcp_f32 v66, v66
v_rcp_f32 v67, v67
v_mul_f32 v56, v56, v64
v_mul_f32 v57, v57, v65
v_mul_f32 v58, v58, v66
v_mul_f32 v59, v59, v67
v_mul_f32 v56, v56, v60
v_mul_f32 v57, v57, v61
v_mul_f32 v58, v58, v62
v_mul_f32 v59, v59, v63
v_cvt_pk_bf16_f32 v56, v56, v57
v_cvt_pk_bf16_f32 v57, v58, v59
s_lshl_b32 s8, s71, 7
v_lshlrev_b32 v45, 3, v35
v_add_u32 v45, s8, v45
s_mov_b64 exec, 0xffff
ds_write_b64 v45, v[56:57] offset:512
s_mov_b64 exec, -1
s_waitcnt lgkmcnt(0)
v_mov_b32 v44, 0
v_mov_b32 v45, 1
s_mov_b64 exec, 1
ds_add_u32 v44, v45 offset:4
s_mov_b64 exec, -1
v_mov_b32 v44, 0
s_mov_b32 s73, 200000
L_sp167:
ds_read_b32 v45, v44 offset:4
s_waitcnt lgkmcnt(0)
v_readfirstlane_b32 s8, v45
s_cmp_ge_u32 s8, 20
s_cbranch_scc1 L_sp167_ok
s_sleep 1
s_sub_u32 s73, s73, 1
s_cbranch_scc0 L_sp167
L_sp167_ok:
v_lshrrev_b32 v45, 3, v35
v_lshlrev_b32 v45, 7, v45
v_lshlrev_b32 v46, 2, v34
v_add_u32 v45, v45, v46
s_lshl_b32 s8, s71, 5
v_add_u32 v45, s8, v45
ds_read_b32 v56, v45 offset:512
ds_read_b32 v57, v45 offset:528
ds_read_b32 v58, v45 offset:768
ds_read_b32 v59, v45 offset:784
s_waitcnt lgkmcnt(0)
v_perm_b32 v8, v56, v56, v16
v_perm_b32 v9, v56, v56, v17
v_perm_b32 v10, v56, v56, v18
v_perm_b32 v11, v56, v56, v19
s_nop 1
v_mfma_f32_16x16x32_bf16 v[4:7], v[8:11], v[120:123], 0
v_perm_b32 v12, v58, v58, v16
v_perm_b32 v13, v58, v58, v17
v_perm_b32 v14, v58, v58, v18
v_perm_b32 v15, v58, v58, v19
s_nop 1
v_mfma_f32_16x16x32_bf16 v[52:55], v[12:15], v[120:123], 0
v_perm_b32 v8, v56, v56, v20
v_perm_b32 v9, v56, v56, v21
v_perm_b32 v10, v56, v56, v22
v_perm_b32 v11, v56, v56, v23
s_nop 1
v_mfma_f32_16x16x32_bf16 v[4:7], v[8:11], v[124:127], v[4:7]
v_perm_b32 v12, v58, v58, v20
v_perm_b32 v13, v58, v58, v21
v_perm_b32 v14, v58, v58, v22
v_perm_b32 v15, v58, v58, v23
s_nop 1
v_mfma_f32_16x16x32_bf16 v[52:55], v[12:15], v[124:127], v[52:55]
v_perm_b32 v8, v57, v57, v16
v_perm_b32 v9, v57, v57, v17
v_perm_b32 v10, v57, v57, v18
v_perm_b32 v11, v57, v57, v19
s_nop 1
v_mfma_f32_16x16x32_bf16 v[4:7], v[8:11], v[128:131], v[4:7]
v_perm_b32 v12, v59, v59, v16
v_perm_b32 v13, v59, v59, v17
v_perm_b32 v14, v59, v59, v18
v_perm_b32 v15, v59, v59, v19
s_nop 1
v_mfma_f32_16x16x32_bf16 v[52:55], v[12:15], v[128:131], v[52:55]
v_perm_b32 v8, v57, v57, v20
v_perm_b32 v9, v57, v57, v21
v_perm_b32 v10, v57, v57, v22
v_perm_b32 v11, v57, v57, v23
s_nop 1
v_mfma_f32_16x16x32_bf16 v[4:7], v[8:11], v[132:135], v[4:7]
v_perm_b32 v12, v59, v59, v20
v_perm_b32 v13, v59, v59, v21
v_perm_b32 v14, v59, v59, v22
v_perm_b32 v15, v59, v59, v23
s_nop 1
v_mfma_f32_16x16x32_bf16 v[52:55], v[12:15], v[132:135], v[52:55]
s_lshl_b32 s8, s71, 11
s_add_u32 s8, s8, 49152
v_lshlrev_b32 v45, 4, v1
v_add_u32 v45, s8, v45
ds_write_b128 v45, v[4:7]
s_nop 2
ds_write_b128 v45, v[52:55] offset:1024
s_waitcnt lgkmcnt(0)
v_mov_b32 v44, 0
v_mov_b32 v45, 1
s_mov_b64 exec, 1
ds_add_u32 v44, v45 offset:4
s_mov_b64 exec, -1
v_mov_b32 v44, 0
s_mov_b32 s73, 200000
L_sp168:
ds_read_b32 v45, v44 offset:4
s_waitcnt lgkmcnt(0)
v_readfirstlane_b32 s8, v45
s_cmp_ge_u32 s8, 24
s_cbranch_scc1 L_sp168_ok
s_sleep 1
s_sub_u32 s73, s73, 1
s_cbranch_scc0 L_sp168
L_sp168_ok:
s_lshr_b32 s8, s71, 1
s_lshl_b32 s8, s8, 10
s_and_b32 s9, s71, 1
s_lshl_b32 s9, s9, 9
s_add_u32 s8, s8, s9
s_add_u32 s8, s8, 49152
v_and_b32 v45, 1, v1
v_lshlrev_b32 v45, 8, v45
v_bfe_u32 v46, v1, 1, 4
v_lshlrev_b32 v46, 4, v46
v_add_u32 v45, v45, v46
v_add_u32 v45, s8, v45
ds_read_b128 v[56:59], v45 offset:0
ds_read_b128 v[60:63], v45 offset:2048
ds_read_b128 v[64:67], v45 offset:4096
ds_read_b128 v[68:71], v45 offset:6144
s_lshl_b32 s10, s77, 2
s_add_u32 s10, s10, s71
s_mul_i32 s10, s10, 27
s_add_u32 s10, s10, s76
s_lshl_b32 s10, s10, 9
s_add_u32 s10, s10, 1572864
v_lshlrev_b32 v46, 4, v1
v_add_u32 v46, s10, v46
s_waitcnt lgkmcnt(0)
v_pk_add_f32 v[56:57], v[56:57], v[60:61]
v_pk_add_f32 v[58:59], v[58:59], v[62:63]
v_pk_add_f32 v[64:65], v[64:65], v[68:69]
v_pk_add_f32 v[66:67], v[66:67], v[70:71]
v_pk_add_f32 v[56:57], v[56:57], v[64:65]
v_pk_add_f32 v[58:59], v[58:59], v[66:67]
v_mul_f32 v56, v56, v32
v_mul_f32 v57, v57, v32
v_mul_f32 v58, v58, v32
v_mul_f32 v59, v59, v32
v_and_or_b32 v56, v56, s14, v28
v_and_or_b32 v57, v57, s14, v29
v_and_or_b32 v58, v58, s14, v30
v_and_or_b32 v59, v59, s14, v31
s_mov_b32 exec_lo, s70
s_mov_b32 exec_hi, 0
global_store_dwordx4 v46, v[56:59], s[40:41] sc1
s_mov_b64 exec, -1
L_noffn:
s_setprio 0
v_lshlrev_b32 v45, 4, v1
v_add_u32 v45, 16384, v45
ds_read_b128 v[128:131], v45 offset:0
ds_read_b128 v[132:135], v45 offset:1024
ds_read_b128 v[136:139], v45 offset:2048
ds_read_b128 v[140:143], v45 offset:3072
ds_read_b128 v[144:147], v45 offset:4096
ds_read_b128 v[148:151], v45 offset:5120
ds_read_b128 v[152:155], v45 offset:6144
ds_read_b128 v[156:159], v45 offset:7168
s_waitcnt lgkmcnt(0)
ds_read_b128 v[160:163], v45 offset:8192
ds_read_b128 v[164:167], v45 offset:9216
ds_read_b128 v[168:171], v45 offset:10240
ds_read_b128 v[172:175], v45 offset:11264
ds_read_b128 v[176:179], v45 offset:12288
ds_read_b128 v[180:183], v45 offset:13312
ds_read_b128 v[184:187], v45 offset:14336
ds_read_b128 v[188:191], v45 offset:15360
s_waitcnt lgkmcnt(0)
ds_read_b128 v[192:195], v45 offset:16384
ds_read_b128 v[196:199], v45 offset:17408
ds_read_b128 v[200:203], v45 offset:18432
ds_read_b128 v[204:207], v45 offset:19456
ds_read_b128 v[208:211], v45 offset:20480
ds_read_b128 v[212:215], v45 offset:21504
ds_read_b128 v[216:219], v45 offset:22528
ds_read_b128 v[220:223], v45 offset:23552
s_waitcnt lgkmcnt(0)
ds_read_b128 v[224:227], v45 offset:24576
ds_read_b128 v[228:231], v45 offset:25600
ds_read_b128 v[232:235], v45 offset:26624
ds_read_b128 v[236:239], v45 offset:27648
ds_read_b128 v[240:243], v45 offset:28672
ds_read_b128 v[244:247], v45 offset:29696
ds_read_b128 v[248:251], v45 offset:30720
ds_read_b128 v[252:255], v45 offset:31744
s_waitcnt lgkmcnt(0)
s_bfe_u32 s9, s2, 0x20003
s_lshl_b32 s9, s9, 1
s_add_u32 s9, s9, 1
s_and_b32 s8, s2, 7
s_cmp_eq_u32 s8, s9
s_cselect_b32 s75, 1, 0
s_lshr_b32 s76, s2, 5
s_bfe_u32 s77, s2, 0x20003
s_cmp_ge_u32 s76, 1
s_cselect_b32 s65, 1, 0
s_add_u32 s65, s65, s76
s_cmp_ge_u32 s76, 5
s_addc_u32 s65, s65, 0
s_lshl_b32 s65, s65, 7
s_and_b32 s69, s76, 3
s_cmp_eq_u32 s69, 0
s_cselect_b32 s69, 16, 8
s_cselect_b32 s70, -1, 0xffff
s_cmp_eq_u32 s75, 1
s_cbranch_scc0 L_nocol
s_lshl_b32 s8, s76, 2
s_add_u32 s8, s8, s77
s_mul_i32 s8, s8, 27
s_add_u32 s8, s8, s71
s_lshl_b32 s8, s8, 9
s_add_u32 s8, s8, 1572864
v_lshrrev_b32 v46, 5, v1
v_lshlrev_b32 v46, 11, v46
v_and_b32 v47, 31, v1
v_lshlrev_b32 v47, 4, v47
v_add_u32 v46, v46, v47
v_add_u32 v46, s8, v46
s_mov_b32 s73, 200000
L_cpoll:
v_mov_b32 v48, v46
s_mov_b32 exec_lo, s70
s_mov_b32 exec_hi, s70
global_load_dwordx4 v[56:59], v48, s[40:41] sc1
s_mov_b64 exec, -1
v_add_u32 v48, 4096, v48
s_mov_b32 exec_lo, s70
s_mov_b32 exec_hi, s70
global_load_dwordx4 v[60:63], v48, s[40:41] sc1
s_mov_b64 exec, -1
v_add_u32 v48, 4096, v48
s_mov_b32 exec_lo, s70
s_mov_b32 exec_hi, s70
global_load_dwordx4 v[64:67], v48, s[40:41] sc1
s_mov_b64 exec, -1
v_add_u32 v48, 4096, v48
s_cmp_lt_u32 s71, 3
s_cbranch_scc0 L_cskip
s_mov_b32 exec_lo, s70
s_mov_b32 exec_hi, 0
global_load_dwordx4 v[68:71], v48, s[40:41] sc1
s_mov_b64 exec, -1
L_cskip:
s_waitcnt vmcnt(0)
v_and_b32 v44, 31, v1
s_lshl_b32 s8, s69, 1
v_cmp_le_u32 vcc, s8, v44
s_nop 1
v_cndmask_b32 v56, v56, v28, vcc
v_cndmask_b32 v57, v57, v29, vcc
v_cndmask_b32 v58, v58, v30, vcc
v_cndmask_b32 v59, v59, v31, vcc
v_cndmask_b32 v60, v60, v28, vcc
v_cndmask_b32 v61, v61, v29, vcc
v_cndmask_b32 v62, v62, v30, vcc
v_cndmask_b32 v63, v63, v31, vcc
v_cndmask_b32 v64, v64, v28, vcc
v_cndmask_b32 v65, v65, v29, vcc
v_cndmask_b32 v66, v66, v30, vcc
v_cndmask_b32 v67, v67, v31, vcc
v_cndmask_b32 v68, v68, v28, vcc
v_cndmask_b32 v69, v69, v29, vcc
v_cndmask_b32 v70, v70, v30, vcc
v_cndmask_b32 v71, v71, v31, vcc
s_cmp_lt_u32 s71, 3
s_cselect_b32 s8, 0xffffffff, 0
s_mov_b32 s9, 0
s_not_b64 vcc, s[8:9]
v_cndmask_b32 v68, v68, v28, vcc
v_cndmask_b32 v69, v69, v29, vcc
v_cndmask_b32 v70, v70, v30, vcc
v_cndmask_b32 v71, v71, v31, vcc
s_mov_b32 s12, 0x0c0c0400
s_mov_b32 s13, 0x04000c0c
v_perm_b32 v44, v57, v56, s12
v_perm_b32 v45, v59, v58, s13
v_or_b32 v44, v44, v45
v_cmp_ne_u32 s[78:79], s74, v44
v_perm_b32 v44, v61, v60, s12
v_perm_b32 v45, v63, v62, s13
v_or_b32 v44, v44, v45
v_cmp_ne_u32 vcc, s74, v44
s_or_b64 s[78:79], s[78:79], vcc
v_perm_b32 v44, v65, v64, s12
v_perm_b32 v45, v67, v66, s13
v_or_b32 v44, v44, v45
v_cmp_ne_u32 vcc, s74, v44
s_or_b64 s[78:79], s[78:79], vcc
v_perm_b32 v44, v69, v68, s12
v_perm_b32 v45, v71, v70, s13
v_or_b32 v44, v44, v45
v_cmp_ne_u32 vcc, s74, v44
s_or_b64 s[78:79], s[78:79], vcc
s_cmp_eq_u64 s[78:79], 0
s_cbranch_scc1 L_cok
s_sleep 64
s_sub_u32 s73, s73, 1
s_cbranch_scc0 L_cpoll
L_cok:
v_pk_add_f32 v[56:57], v[56:57], v[60:61]
v_pk_add_f32 v[58:59], v[58:59], v[62:63]
v_pk_add_f32 v[64:65], v[64:65], v[68:69]
v_pk_add_f32 v[66:67], v[66:67], v[70:71]
v_pk_add_f32 v[56:57], v[56:57], v[64:65]
v_pk_add_f32 v[58:59], v[58:59], v[66:67]
v_mov_b32 v60, v56
v_mov_b32 v61, v57
v_mov_b32 v62, v58
v_mov_b32 v63, v59
v_permlane32_swap_b32 v56, v60
v_permlane32_swap_b32 v57, v61
v_permlane32_swap_b32 v58, v62
v_permlane32_swap_b32 v59, v63
v_add_f32 v56, v56, v60
v_add_f32 v57, v57, v61
v_add_f32 v58, v58, v62
v_add_f32 v59, v59, v63
s_lshl_b32 s8, s71, 9
v_lshlrev_b32 v45, 4, v1
v_add_u32 v45, s8, v45
s_mov_b32 exec_hi, 0
ds_write_b128 v45, v[56:59] offset:6144
s_mov_b32 exec_hi, -1
s_waitcnt lgkmcnt(0)
v_mov_b32 v44, 0
v_mov_b32 v45, 1
s_mov_b64 exec, 1
ds_add_u32 v44, v45 offset:4
s_mov_b64 exec, -1
v_mov_b32 v44, 0
s_mov_b32 s73, 200000
L_sp169:
ds_read_b32 v45, v44 offset:4
s_waitcnt lgkmcnt(0)
v_readfirstlane_b32 s8, v45
s_cmp_ge_u32 s8, 16
s_cbranch_scc1 L_sp169_ok
s_sleep 1
s_sub_u32 s73, s73, 1
s_cbranch_scc0 L_sp169
L_sp169_ok:
v_lshlrev_b32 v45, 4, v1
s_mov_b32 exec_hi, 0
ds_read_b128 v[56:59], v45 offset:6144
ds_read_b128 v[60:63], v45 offset:6656
ds_read_b128 v[64:67], v45 offset:7168
ds_read_b128 v[68:71], v45 offset:7680
s_mov_b32 exec_hi, -1
s_waitcnt lgkmcnt(0)
v_pk_add_f32 v[56:57], v[56:57], v[60:61]
v_pk_add_f32 v[58:59], v[58:59], v[62:63]
v_pk_add_f32 v[64:65], v[64:65], v[68:69]
v_pk_add_f32 v[66:67], v[66:67], v[70:71]
v_pk_add_f32 v[56:57], v[56:57], v[64:65]
v_pk_add_f32 v[58:59], v[58:59], v[66:67]
v_mov_b32 v36, v56
v_mov_b32 v37, v57
v_mov_b32 v38, v58
v_mov_b32 v39, v59
L_nocol:
s_cmp_eq_u32 s71, 1
s_cbranch_scc0 L_noctl
s_lshl_b32 s8, s2, 7
s_add_u32 s8, s8, 32768
v_mov_b32 v46, s8
v_add_u32 v47, 1, v1
v_xor_b32 v47, s2, v47
v_lshlrev_b32 v47, 7, v47
v_add_u32 v47, 32768, v47
v_mov_b32 v44, 0
v_mov_b32 v48, s74
s_mov_b32 s11, 0
L_ctl:
s_mov_b64 exec, 1
s_add_u32 s11, s11, 1
s_lshl_b32 s9, s11, 2
s_sub_u32 s9, s9, 1
s_mov_b32 s73, 200000
L_ctl_w:
ds_read_b32 v45, v44 offset:16
s_waitcnt lgkmcnt(0)
v_readfirstlane_b32 s8, v45
s_cmp_ge_u32 s8, s9
s_cbranch_scc1 L_ctl_go
s_sleep 4
s_sub_u32 s73, s73, 1
s_cbranch_scc0 L_ctl_w
L_ctl_go:
global_store_dword v46, v48, s[40:41] sc1
s_mov_b64 exec, 0x7f
global_load_dword v45, v47, s[40:41] sc1
s_waitcnt vmcnt(0)
v_cmp_eq_u32 vcc, s74, v45
s_bcnt1_i32_b64 s8, vcc
s_cmp_ge_u32 s8, 99
s_cselect_b32 s9, 1, 0
s_cmp_ge_u32 s8, 4
s_cselect_b32 s8, 1, 0
s_add_u32 s8, s8, s9
s_mov_b64 exec, -1
v_mov_b32 v45, s8
ds_write_b32 v44, v45 offset:20
v_add_u32 v46, 4, v46
v_add_u32 v47, 4, v47
s_cmp_lt_u32 s11, 6
s_cbranch_scc1 L_ctl
s_mov_b64 exec, -1
s_branch L_B2
L_noctl:
v_mov_b32 v44, 0
s_mov_b32 s73, 200000
L_sp170:
ds_read_b32 v45, v44 offset:0
s_waitcnt lgkmcnt(0)
v_readfirstlane_b32 s8, v45
s_cmp_ge_u32 s8, 4
s_cbranch_scc1 L_sp170_ok
s_sleep 8
s_sub_u32 s73, s73, 1
s_cbranch_scc0 L_sp170
L_sp170_ok:
s_cmp_eq_u32 s71, 0
s_cbranch_scc0 L_nostat
v_and_b32 v44, 3, v1
v_lshlrev_b32 v44, 3, v44
ds_read_b64 v[46:47], v44 offset:40
s_waitcnt lgkmcnt(0)
v_mov_b32 v48, v46
s_nop 1
v_max_f32_dpp v48, v48, v48 quad_perm:[2,3,0,1] row_mask:0xf bank_mask:0xf
s_nop 1
v_max_f32_dpp v48, v48, v48 quad_perm:[1,0,3,2] row_mask:0xf bank_mask:0xf
v_sub_f32 v49, v46, v48
v_exp_f32 v49, v49
s_nop 0
v_mul_f32 v49, v49, v47
s_nop 1
v_add_f32_dpp v49, v49, v49 quad_perm:[2,3,0,1] row_mask:0xf bank_mask:0xf
s_nop 1
v_add_f32_dpp v49, v49, v49 quad_perm:[1,0,3,2] row_mask:0xf bank_mask:0xf
s_lshl_b32 s8, s2, 7
s_add_u32 s8, s8, 0
v_mov_b32 v44, s8
v_mov_b32 v56, v48
v_mov_b32 v57, s74
v_mov_b32 v58, v49
v_mov_b32 v59, s74
s_mov_b64 exec, 1
global_store_dwordx4 v44, v[56:59], s[40:41] sc1
s_xor_b32 s8, s2, 32
s_lshl_b32 s8, s8, 7
s_add_u32 s8, s8, 0
v_mov_b32 v44, s8
s_mov_b32 s73, 200000
L_pspin:
global_load_dwordx4 v[60:63], v44, s[40:41] sc1
s_waitcnt vmcnt(0)
v_cmp_ne_u32 s[78:79], s74, v61
v_cmp_ne_u32 vcc, s74, v63
s_or_b64 s[78:79], s[78:79], vcc
s_cmp_eq_u64 s[78:79], 0
s_cbranch_scc1 L_pok
s_sleep 32
s_sub_u32 s73, s73, 1
s_cbranch_scc0 L_pspin
L_pok:
v_readfirstlane_b32 s8, v60
v_readfirstlane_b32 s9, v62
s_mov_b64 exec, -1
v_mov_b32 v60, s8
v_mov_b32 v62, s9
v_max_f32 v52, v48, v60
v_sub_f32 v53, v48, v52
v_sub_f32 v54, v60, v52
v_exp_f32 v53, v53
v_exp_f32 v54, v54
v_mul_f32 v53, v53, v49
v_fma_f32 v53, v54, v62, v53
v_rcp_f32 v53, v53
v_sub_f32 v54, v46, v52
v_exp_f32 v54, v54
s_nop 0
v_mul_f32 v54, v54, v53
v_and_b32 v44, 3, v1
v_lshlrev_b32 v44, 2, v44
v_mov_b32 v45, 1
v_mov_b32 v55, 0
s_mov_b64 exec, 15
ds_write_b32 v44, v54 offset:72
s_mov_b64 exec, 1
ds_write_b32 v55, v45 offset:8
s_mov_b64 exec, -1
L_nostat:
L_B2:
s_setprio 3
s_lshl_b32 s10, s71, 6
s_lshl_b32 s9, s4, 1
s_add_u32 s10, s10, s9
s_lshl_b32 s10, s10, 9
s_add_u32 s10, s10, 917504
v_lshlrev_b32 v46, 4, v1
v_add_u32 v46, s10, v46
v_lshlrev_b32 v49, 9, v1
v_add_u32 v49, s10, v49
v_and_b32 v47, 1, v1
v_lshlrev_b32 v47, 7, v47
v_bfe_u32 v48, v1, 1, 4
v_lshlrev_b32 v48, 2, v48
v_add_u32 v47, v47, v48
s_lshl_b32 s8, s71, 8
v_add_u32 v47, s8, v47
v_add_u32 v47, 1024, v47
v_lshlrev_b32 v48, 6, v34
v_add_u32 v48, s8, v48
v_lshlrev_b32 v41, 5, v35
v_lshlrev_b32 v42, 4, v34
v_add_u32 v41, v41, v42
s_lshl_b32 s8, s71, 9
v_add_u32 v41, s8, v41
v_lshlrev_b32 v42, 4, v1
v_add_u32 v42, s8, v42
s_lshl_b32 s10, s72, 2
s_add_u32 s10, s10, s71
s_lshl_b32 s10, s10, 5
s_add_u32 s10, s10, s4
s_lshl_b32 s10, s10, 9
s_add_u32 s10, s10, 1048576
v_lshlrev_b32 v43, 5, v35
v_lshlrev_b32 v44, 4, v34
v_add_u32 v43, v43, v44
v_add_u32 v43, s10, v43
s_cmp_eq_u32 s67, 16
s_cselect_b32 s43, -1, 0x00ff00ff
s_waitcnt lgkmcnt(0)
s_barrier
s_mov_b32 s73, 200000
L_opoll:
global_load_dwordx4 v[56:59], v46, s[40:41] sc1
s_waitcnt vmcnt(0)
s_mov_b32 s12, 0x0c0c0400
s_mov_b32 s13, 0x04000c0c
v_perm_b32 v44, v57, v56, s12
v_perm_b32 v45, v59, v58, s13
v_or_b32 v44, v44, v45
v_cmp_ne_u32 s[78:79], s74, v44
s_cmp_eq_u64 s[78:79], 0
s_cbranch_scc1 L_ook
s_sub_u32 s73, s73, 1
s_cbranch_scc0 L_opoll
L_ook:
v_mov_b32 v60, v56
v_mov_b32 v61, v57
v_mov_b32 v62, v58
v_mov_b32 v63, v59
v_permlane32_swap_b32 v56, v60
v_permlane32_swap_b32 v57, v61
v_permlane32_swap_b32 v58, v62
v_permlane32_swap_b32 v59, v63
v_add_f32 v56, v56, v60
v_add_f32 v57, v57, v61
v_add_f32 v58, v58, v62
v_add_f32 v59, v59, v63
v_cvt_pk_bf16_f32 v56, v56, v57
v_cvt_pk_bf16_f32 v57, v58, v59
s_mov_b32 exec_hi, 0
ds_write2_b32 v47, v56, v57 offset0:0 offset1:16
s_mov_b32 exec_hi, -1
ds_read_b128 v[64:67], v48 offset:1024
ds_read_b128 v[68:71], v48 offset:1040
ds_read_b128 v[72:75], v48 offset:1056
ds_read_b128 v[76:79], v48 offset:1072
s_waitcnt lgkmcnt(3)
v_perm_b32 v8, v64, v64, v16
v_perm_b32 v9, v64, v64, v17
v_perm_b32 v10, v64, v64, v18
v_perm_b32 v11, v64, v64, v19
v_perm_b32 v12, v64, v64, v20
v_perm_b32 v13, v64, v64, v21
v_perm_b32 v14, v64, v64, v22
v_perm_b32 v15, v64, v64, v23
v_mfma_f32_16x16x32_bf16 v[4:7], v[8:11], v[128:131], 0
v_perm_b32 v8, v65, v65, v16
v_perm_b32 v9, v65, v65, v17
v_perm_b32 v10, v65, v65, v18
v_perm_b32 v11, v65, v65, v19
v_mfma_f32_16x16x32_bf16 v[4:7], v[12:15], v[132:135], v[4:7]
v_perm_b32 v12, v65, v65, v20
v_perm_b32 v13, v65, v65, v21
v_perm_b32 v14, v65, v65, v22
v_perm_b32 v15, v65, v65, v23
v_mfma_f32_16x16x32_bf16 v[4:7], v[8:11], v[136:139], v[4:7]
v_perm_b32 v8, v66, v66, v16
v_perm_b32 v9, v66, v66, v17
v_perm_b32 v10, v66, v66, v18
v_perm_b32 v11, v66, v66, v19
v_mfma_f32_16x16x32_bf16 v[4:7], v[12:15], v[140:143], v[4:7]
v_perm_b32 v12, v66, v66, v20
v_perm_b32 v13, v66, v66, v21
v_perm_b32 v14, v66, v66, v22
v_perm_b32 v15, v66, v66, v23
v_mfma_f32_16x16x32_bf16 v[4:7], v[8:11], v[144:147], v[4:7]
v_perm_b32 v8, v67, v67, v16
v_perm_b32 v9, v67, v67, v17
v_perm_b32 v10, v67, v67, v18
v_perm_b32 v11, v67, v67, v19
v_mfma_f32_16x16x32_bf16 v[4:7], v[12:15], v[148:151], v[4:7]
v_perm_b32 v12, v67, v67, v20
v_perm_b32 v13, v67, v67, v21
v_perm_b32 v14, v67, v67, v22
v_perm_b32 v15, v67, v67, v23
v_mfma_f32_16x16x32_bf16 v[4:7], v[8:11], v[152:155], v[4:7]
s_waitcnt lgkmcnt(2)
v_perm_b32 v8, v68, v68, v16
v_perm_b32 v9, v68, v68, v17
v_perm_b32 v10, v68, v68, v18
v_perm_b32 v11, v68, v68, v19
v_mfma_f32_16x16x32_bf16 v[4:7], v[12:15], v[156:159], v[4:7]
v_perm_b32 v12, v68, v68, v20
v_perm_b32 v13, v68, v68, v21
v_perm_b32 v14, v68, v68, v22
v_perm_b32 v15, v68, v68, v23
v_mfma_f32_16x16x32_bf16 v[4:7], v[8:11], v[160:163], v[4:7]
v_perm_b32 v8, v69, v69, v16
v_perm_b32 v9, v69, v69, v17
v_perm_b32 v10, v69, v69, v18
v_perm_b32 v11, v69, v69, v19
v_mfma_f32_16x16x32_bf16 v[4:7], v[12:15], v[164:167], v[4:7]
v_perm_b32 v12, v69, v69, v20
v_perm_b32 v13, v69, v69, v21
v_perm_b32 v14, v69, v69, v22
v_perm_b32 v15, v69, v69, v23
v_mfma_f32_16x16x32_bf16 v[4:7], v[8:11], v[168:171], v[4:7]
v_perm_b32 v8, v70, v70, v16
v_perm_b32 v9, v70, v70, v17
v_perm_b32 v10, v70, v70, v18
v_perm_b32 v11, v70, v70, v19
v_mfma_f32_16x16x32_bf16 v[4:7], v[12:15], v[172:175], v[4:7]
v_perm_b32 v12, v70, v70, v20
v_perm_b32 v13, v70, v70, v21
v_perm_b32 v14, v70, v70, v22
v_perm_b32 v15, v70, v70, v23
v_mfma_f32_16x16x32_bf16 v[4:7], v[8:11], v[176:179], v[4:7]
v_perm_b32 v8, v71, v71, v16
v_perm_b32 v9, v71, v71, v17
v_perm_b32 v10, v71, v71, v18
v_perm_b32 v11, v71, v71, v19
v_mfma_f32_16x16x32_bf16 v[4:7], v[12:15], v[180:183], v[4:7]
v_perm_b32 v12, v71, v71, v20
v_perm_b32 v13, v71, v71, v21
v_perm_b32 v14, v71, v71, v22
v_perm_b32 v15, v71, v71, v23
v_mfma_f32_16x16x32_bf16 v[4:7], v[8:11], v[184:187], v[4:7]
s_waitcnt lgkmcnt(1)
v_perm_b32 v8, v72, v72, v16
v_perm_b32 v9, v72, v72, v17
v_perm_b32 v10, v72, v72, v18
v_perm_b32 v11, v72, v72, v19
v_mfma_f32_16x16x32_bf16 v[4:7], v[12:15], v[188:191], v[4:7]
v_perm_b32 v12, v72, v72, v20
v_perm_b32 v13, v72, v72, v21
v_perm_b32 v14, v72, v72, v22
v_perm_b32 v15, v72, v72, v23
v_mfma_f32_16x16x32_bf16 v[4:7], v[8:11], v[192:195], v[4:7]
v_perm_b32 v8, v73, v73, v16
v_perm_b32 v9, v73, v73, v17
v_perm_b32 v10, v73, v73, v18
v_perm_b32 v11, v73, v73, v19
v_mfma_f32_16x16x32_bf16 v[4:7], v[12:15], v[196:199], v[4:7]
v_perm_b32 v12, v73, v73, v20
v_perm_b32 v13, v73, v73, v21
v_perm_b32 v14, v73, v73, v22
v_perm_b32 v15, v73, v73, v23
v_mfma_f32_16x16x32_bf16 v[4:7], v[8:11], v[200:203], v[4:7]
v_perm_b32 v8, v74, v74, v16
v_perm_b32 v9, v74, v74, v17
v_perm_b32 v10, v74, v74, v18
v_perm_b32 v11, v74, v74, v19
v_mfma_f32_16x16x32_bf16 v[4:7], v[12:15], v[204:207], v[4:7]
v_perm_b32 v12, v74, v74, v20
v_perm_b32 v13, v74, v74, v21
v_perm_b32 v14, v74, v74, v22
v_perm_b32 v15, v74, v74, v23
v_mfma_f32_16x16x32_bf16 v[4:7], v[8:11], v[208:211], v[4:7]
v_perm_b32 v8, v75, v75, v16
v_perm_b32 v9, v75, v75, v17
v_perm_b32 v10, v75, v75, v18
v_perm_b32 v11, v75, v75, v19
v_mfma_f32_16x16x32_bf16 v[4:7], v[12:15], v[212:215], v[4:7]
v_perm_b32 v12, v75, v75, v20
v_perm_b32 v13, v75, v75, v21
v_perm_b32 v14, v75, v75, v22
v_perm_b32 v15, v75, v75, v23
v_mfma_f32_16x16x32_bf16 v[4:7], v[8:11], v[216:219], v[4:7]
s_waitcnt lgkmcnt(0)
v_perm_b32 v8, v76, v76, v16
v_perm_b32 v9, v76, v76, v17
v_perm_b32 v10, v76, v76, v18
v_perm_b32 v11, v76, v76, v19
v_mfma_f32_16x16x32_bf16 v[4:7], v[12:15], v[220:223], v[4:7]
v_perm_b32 v12, v76, v76, v20
v_perm_b32 v13, v76, v76, v21
v_perm_b32 v14, v76, v76, v22
v_perm_b32 v15, v76, v76, v23
v_mfma_f32_16x16x32_bf16 v[4:7], v[8:11], v[224:227], v[4:7]
v_perm_b32 v8, v77, v77, v16
v_perm_b32 v9, v77, v77, v17
v_perm_b32 v10, v77, v77, v18
v_perm_b32 v11, v77, v77, v19
v_mfma_f32_16x16x32_bf16 v[4:7], v[12:15], v[228:231], v[4:7]
v_perm_b32 v12, v77, v77, v20
v_perm_b32 v13, v77, v77, v21
v_perm_b32 v14, v77, v77, v22
v_perm_b32 v15, v77, v77, v23
v_mfma_f32_16x16x32_bf16 v[4:7], v[8:11], v[232:235], v[4:7]
v_perm_b32 v8, v78, v78, v16
v_perm_b32 v9, v78, v78, v17
v_perm_b32 v10, v78, v78, v18
v_perm_b32 v11, v78, v78, v19
v_mfma_f32_16x16x32_bf16 v[4:7], v[12:15], v[236:239], v[4:7]
v_perm_b32 v12, v78, v78, v20
v_perm_b32 v13, v78, v78, v21
v_perm_b32 v14, v78, v78, v22
v_perm_b32 v15, v78, v78, v23
v_mfma_f32_16x16x32_bf16 v[4:7], v[8:11], v[240:243], v[4:7]
v_perm_b32 v8, v79, v79, v16
v_perm_b32 v9, v79, v79, v17
v_perm_b32 v10, v79, v79, v18
v_perm_b32 v11, v79, v79, v19
v_mfma_f32_16x16x32_bf16 v[4:7], v[12:15], v[244:247], v[4:7]
v_perm_b32 v12, v79, v79, v20
v_perm_b32 v13, v79, v79, v21
v_perm_b32 v14, v79, v79, v22
v_perm_b32 v15, v79, v79, v23
v_mfma_f32_16x16x32_bf16 v[4:7], v[8:11], v[248:251], v[4:7]
s_nop 0
v_mfma_f32_16x16x32_bf16 v[4:7], v[12:15], v[252:255], v[4:7]
s_nop 7
v_mul_f32 v4, v4, v33
v_mul_f32 v5, v5, v33
v_mul_f32 v6, v6, v33
v_mul_f32 v7, v7, v33
v_and_or_b32 v4, v4, s14, v28
v_and_or_b32 v5, v5, s14, v29
v_and_or_b32 v6, v6, s14, v30
v_and_or_b32 v7, v7, s14, v31
s_mov_b32 exec_lo, s43
s_mov_b32 exec_hi, 0
global_store_dwordx4 v43, v[4:7], s[40:41] sc1
s_mov_b64 exec, -1
s_cmp_eq_u32 s75, 1
s_cbranch_scc0 L_hend
s_lshl_b32 s10, s76, 2
s_add_u32 s10, s10, s77
s_lshl_b32 s10, s10, 5
s_lshl_b32 s9, s71, 3
s_add_u32 s10, s10, s9
s_lshl_b32 s10, s10, 9
s_add_u32 s10, s10, 1048576
v_lshrrev_b32 v46, 5, v1
v_lshlrev_b32 v46, 9, v46
v_and_b32 v47, 31, v1
v_lshlrev_b32 v47, 4, v47
v_add_u32 v46, v46, v47
v_add_u32 v46, s10, v46
v_add_u32 v47, 2048, v46
s_mov_b32 s73, 200000
s_mov_b32 s52, s70
s_mov_b32 s53, s70
s_mov_b64 s[54:55], s[52:53]
s_mov_b64 s[56:57], s[52:53]
s_mov_b64 s[58:59], s[52:53]
s_mov_b32 s12, 0x0c0c0400
s_mov_b32 s13, 0x04000c0c
L_ypoll:
s_mov_b64 exec, s[52:53]
s_cbranch_execz L_ysk0
global_load_dwordx4 v[56:59], v46, s[40:41] offset:0 sc1
L_ysk0:
s_mov_b64 exec, s[54:55]
s_cbranch_execz L_ysk1
global_load_dwordx4 v[60:63], v46, s[40:41] offset:1024 sc1
L_ysk1:
s_mov_b64 exec, s[56:57]
s_cbranch_execz L_ysk2
global_load_dwordx4 v[64:67], v47, s[40:41] offset:0 sc1
L_ysk2:
s_mov_b64 exec, s[58:59]
s_cbranch_execz L_ysk3
global_load_dwordx4 v[68:71], v47, s[40:41] offset:1024 sc1
L_ysk3:
s_mov_b32 exec_lo, s70
s_mov_b32 exec_hi, s70
s_waitcnt vmcnt(0)
v_perm_b32 v44, v57, v56, s12
v_perm_b32 v45, v59, v58, s13
v_or_b32 v44, v44, v45
v_cmp_ne_u32 s[52:53], s74, v44
v_perm_b32 v44, v61, v60, s12
v_perm_b32 v45, v63, v62, s13
v_or_b32 v44, v44, v45
v_cmp_ne_u32 s[54:55], s74, v44
v_perm_b32 v44, v65, v64, s12
v_perm_b32 v45, v67, v66, s13
v_or_b32 v44, v44, v45
v_cmp_ne_u32 s[56:57], s74, v44
v_perm_b32 v44, v69, v68, s12
v_perm_b32 v45, v71, v70, s13
v_or_b32 v44, v44, v45
v_cmp_ne_u32 s[58:59], s74, v44
s_or_b64 s[8:9], s[52:53], s[54:55]
s_or_b64 s[10:11], s[56:57], s[58:59]
s_or_b64 s[8:9], s[8:9], s[10:11]
s_cbranch_scc0 L_yok
s_sub_u32 s73, s73, 1
s_cbranch_scc0 L_ypoll
L_yok:
s_mov_b64 exec, -1
v_pk_add_f32 v[56:57], v[56:57], v[60:61]
v_pk_add_f32 v[58:59], v[58:59], v[62:63]
v_pk_add_f32 v[64:65], v[64:65], v[68:69]
v_pk_add_f32 v[66:67], v[66:67], v[70:71]
v_pk_add_f32 v[56:57], v[56:57], v[64:65]
v_pk_add_f32 v[58:59], v[58:59], v[66:67]
v_mov_b32 v60, v56
v_mov_b32 v61, v57
v_mov_b32 v62, v58
v_mov_b32 v63, v59
v_permlane32_swap_b32 v56, v60
v_permlane32_swap_b32 v57, v61
v_permlane32_swap_b32 v58, v62
v_permlane32_swap_b32 v59, v63
v_add_f32 v56, v56, v60
v_add_f32 v57, v57, v61
v_add_f32 v58, v58, v62
v_add_f32 v59, v59, v63
s_lshl_b32 s8, s71, 9
v_lshlrev_b32 v45, 4, v1
v_add_u32 v45, s8, v45
s_mov_b32 exec_hi, 0
ds_write_b128 v45, v[56:59] offset:6144
s_mov_b32 exec_hi, -1
s_waitcnt lgkmcnt(0)
s_barrier
s_cmp_eq_u32 s71, 0
s_cbranch_scc0 L_hend
v_lshlrev_b32 v45, 4, v1
s_mov_b32 exec_lo, s70
s_mov_b32 exec_hi, 0
ds_read_b128 v[56:59], v45 offset:6144
ds_read_b128 v[60:63], v45 offset:6656
ds_read_b128 v[64:67], v45 offset:7168
ds_read_b128 v[68:71], v45 offset:7680
s_mul_i32 s8, s77, 1280
s_add_u32 s8, s8, s65
v_lshlrev_b32 v44, 3, v1
v_add_u32 v44, s8, v44
s_waitcnt lgkmcnt(0)
v_pk_add_f32 v[56:57], v[56:57], v[60:61]
v_pk_add_f32 v[58:59], v[58:59], v[62:63]
v_pk_add_f32 v[64:65], v[64:65], v[68:69]
v_pk_add_f32 v[66:67], v[66:67], v[70:71]
v_pk_add_f32 v[56:57], v[56:57], v[64:65]
v_pk_add_f32 v[58:59], v[58:59], v[66:67]
v_pk_add_f32 v[56:57], v[56:57], v[36:37]
v_pk_add_f32 v[58:59], v[58:59], v[38:39]
v_cvt_pk_bf16_f32 v56, v56, v57
v_cvt_pk_bf16_f32 v57, v58, v59
global_store_dwordx2 v44, v[56:57], s[36:37]
s_mov_b64 exec, -1
L_hend:
L_end:
s_endpgm
.section .rodata,"a"
.p2align 6
.amdhsa_kernel gated_mix__mha_block_cached__swiglu_ffn__decode_kernel
  .amdhsa_next_free_vgpr 256
  .amdhsa_next_free_sgpr 102
  .amdhsa_accum_offset 256
  .amdhsa_group_segment_fixed_size 0
  .amdhsa_kernarg_size 104
  .amdhsa_user_sgpr_count 2
  .amdhsa_user_sgpr_kernarg_segment_ptr 1
  .amdhsa_system_sgpr_workgroup_id_x 1
.end_amdhsa_kernel
```
